```python
import torch

def _softmax(x, axis=-1):
    return torch.softmax(x, dim=axis)
def _gelu(x):
    return torch.nn.functional.gelu(x, approximate="tanh")
def _silu(x):
    return torch.nn.functional.silu(x)
def _sigmoid(x):
    return torch.sigmoid(x)
def _layernorm(x, axis=-1, eps=1e-5):
    m = x.mean(dim=axis, keepdim=True)
    v = x.var(dim=axis, keepdim=True, unbiased=False)
    return (x - m) / torch.sqrt(v + eps)
def _scatter_add(tgt, idx, src, axis=0):
    return tgt.clone().index_add_(axis, idx, src)
def _segment_sum(src, seg, n):
    out = torch.zeros((n,) + src.shape[1:], dtype=src.dtype)
    return out.index_add_(0, seg, src)
def _pad(x, pw):
    flat = tuple(v for pair in reversed(pw) for v in pair)
    return torch.nn.functional.pad(x, flat)

kernel_name = 'standalone__mha_softmax__near_ridge'

def setup_inputs():

    _w = (lambda a: (lambda t: t.to(torch.bfloat16) if t.is_floating_point() else t)(torch.as_tensor(a)))
    B, H, Sq, Sk, D = 8, 32, 368, 512, 128
    return {
        "q": _w((lambda *s: torch.randn(*s, dtype=torch.bfloat16) * 0.8)(B, H, Sq, D)),
        "k": _w((lambda *s: torch.randn(*s, dtype=torch.bfloat16) * 0.8)(B, H, Sk, D)),
        "v": _w((lambda *s: torch.randn(*s, dtype=torch.bfloat16) * 0.05)(B, H, Sk, D)),
    }

def reference(q, k, v):
    scale = q.shape[-1] ** -0.5
    scores = torch.einsum("bhqd,bhkd->bhqk", q, k) * scale
    p = _softmax(scores, axis=-1)
    return torch.einsum("bhqk,bhkd->bhqd", p, v)
```

```asm
; @launch grid=(256,1,1) block=(256,1,1) lds=163840
.amdgcn_target "amdgcn-amd-amdhsa--gfx950"
.text
.globl standalone__mha_softmax__near_ridge_kernel
.p2align 8
.type standalone__mha_softmax__near_ridge_kernel,@function
standalone__mha_softmax__near_ridge_kernel:
    s_load_dwordx8 s[36:43], s[0:1], 0
    s_cmp_ge_u32 s2, 256
    s_cbranch_scc1 L_end
    s_getpc_b64 s[94:95]
    s_lshr_b32 s93, s2, 3
    s_mul_i32 s92, s93, 9363
    s_lshr_b32 s92, s92, 16
    s_mul_i32 s92, s92, 7
    s_sub_u32 s93, s93, s92
    s_lshl_b32 s93, s93, 12
    v_lshl_add_u32 v64, v0, 4, s93
    v_mov_b32 v67, s95
    v_add_co_u32 v66, vcc, s94, v64
    s_nop 1
    v_addc_co_u32 v67, vcc, 0, v67, vcc
    global_load_dwordx4 a[0:3], v[66:67], off
    v_lshrrev_b32 v60, 6, v0
    v_and_b32 v61, 63, v0
    v_lshlrev_b32 v62, 11, v60
    v_lshl_add_u32 v1, v61, 4, v62
    v_readfirstlane_b32 s20, v60
    s_and_b32 s31, s2, 7
    s_lshl_b32 s31, s31, 5
    s_lshr_b32 s28, s2, 3
    s_add_u32 s31, s31, s28
    s_lshl_b32 s29, s31, 17
    s_mul_i32 s28, s31, 94208
    s_mul_i32 s24, s20, 4160
    s_lshl_b32 s23, s2, 10
    s_and_b32 s23, s23, 0x1e000
    s_add_u32 s25, s23, 32
    s_add_u32 s3, s23, 8
    s_mov_b32 s10, 131104
    s_mov_b32 s11, 0x20000
    s_mov_b32 s6, 94208
    s_mov_b32 s7, 0x20000
    s_mov_b32 s14, 133160
    s_mov_b32 s15, 0x20000
    s_lshl_b32 s33, s20, 14
    s_add_u32 s33, s33, 98240
    s_mov_b32 s27, s24
    v_bfe_u32 v62, v0, 4, 2
    v_and_b32 v63, 15, v0
    v_xor_b32 v10, v62, v63
    v_lshlrev_b32 v10, 4, v10
    v_lshl_add_u32 v11, v62, 8, v10
    v_mul_u32_u24 v4, 24576, v60
    v_add_u32 v248, v4, v11
    v_xor_b32 v249, 64, v11
    v_add_u32 v249, v4, v249
    v_xor_b32 v250, 128, v11
    v_add_u32 v250, v4, v250
    v_xor_b32 v251, 192, v11
    v_add_u32 v251, v4, v251
    s_waitcnt lgkmcnt(0)
    s_add_u32 s8, s38, s29
    s_addc_u32 s9, s39, 0
    s_sub_u32 s8, s8, 32
    s_subb_u32 s9, s9, 0
    s_add_u32 s12, s40, s29
    s_addc_u32 s13, s41, 0
    s_sub_u32 s12, s12, 2088
    s_subb_u32 s13, s13, 0
    s_add_u32 s4, s36, s28
    s_addc_u32 s5, s37, 0
    s_add_u32 m0, s33, 0
    s_movk_i32 s34, 0
    buffer_load_dwordx4 v248, s[4:7], s34 offen offset:0 nt lds
    buffer_load_dwordx4 v249, s[4:7], s34 offen offset:1024 nt lds
    buffer_load_dwordx4 v250, s[4:7], s34 offen offset:2048 nt lds
    buffer_load_dwordx4 v251, s[4:7], s34 offen offset:3072 nt lds
    s_mov_b32 m0, s24
    s_nop 0
    buffer_load_dwordx4 v1, s[8:11], s25 offen nt lds
    buffer_load_dwordx4 v1, s[8:11], s23 offen offset:1056 nt lds
    buffer_load_dwordx4 v1, s[12:15], s3 offen offset:2080 nt lds
    buffer_load_dwordx4 v1, s[12:15], s23 offen offset:3112 nt lds
    s_add_u32 s24, s24, 16640
    s_add_u32 s23, s23, 8192
    s_and_b32 s23, s23, 0x1ffff
    s_add_u32 s25, s23, 32
    s_add_u32 s3, s23, 8
    s_mov_b32 m0, s24
    s_nop 0
    buffer_load_dwordx4 v1, s[8:11], s25 offen nt lds
    buffer_load_dwordx4 v1, s[8:11], s23 offen offset:1056 nt lds
    buffer_load_dwordx4 v1, s[12:15], s3 offen offset:2080 nt lds
    buffer_load_dwordx4 v1, s[12:15], s23 offen offset:3112 nt lds
    s_add_u32 s16, s42, s28
    s_addc_u32 s17, s43, 0
    s_mov_b32 s18, 94208
    s_mov_b32 s19, 0x20000
    v_lshl_add_u32 v11, v63, 8, v10
    v_add_u32 v252, s33, v11
    v_xor_b32 v253, 64, v11
    v_add_u32 v253, s33, v253
    v_xor_b32 v254, 128, v11
    v_add_u32 v254, s33, v254
    v_xor_b32 v255, 192, v11
    v_add_u32 v255, s33, v255
    v_bfe_u32 v10, v0, 1, 2
    v_mul_u32_u24 v2, 4160, v10
    v_and_b32 v10, 1, v0
    v_mul_u32_u24 v10, 1056, v10
    v_add_u32 v2, v2, v10
    v_bfe_u32 v10, v0, 3, 1
    v_lshl_add_u32 v2, v10, 8, v2
    v_bfe_u32 v10, v0, 4, 2
    v_lshl_add_u32 v2, v10, 4, v2
    v_bfe_u32 v10, v0, 3, 2
    v_mul_u32_u24 v3, 4160, v10
    v_bfe_u32 v10, v0, 2, 1
    v_mul_u32_u24 v10, 1032, v10
    v_add_u32 v3, v3, v10
    v_bfe_u32 v10, v0, 5, 1
    v_lshl_add_u32 v3, v10, 8, v3
    v_and_b32 v10, 3, v0
    v_lshl_add_u32 v3, v10, 4, v3
    v_add_u32 v3, 2080, v3
    v_bfe_u32 v10, v0, 2, 2
    v_bfe_u32 v11, v0, 4, 2
    v_cmp_eq_u32 vcc, v10, v11
    v_and_b32 v10, 1, v0
    v_lshlrev_b32 v10, 4, v10
    v_mov_b32 v36, 0x3e03
    v_mov_b32 v37, 0xb9d8
    v_lshlrev_b32 v36, v10, v36
    v_lshlrev_b32 v37, v10, v37
    v_cndmask_b32 v36, 0, v36, vcc
    v_cndmask_b32 v37, 0, v37, vcc
    v_and_b32 v10, 2, v0
    v_cmp_eq_u32 vcc, 0, v10
    v_accvgpr_write_b32 a224, 0
    v_accvgpr_write_b32 a225, 0
    v_accvgpr_write_b32 a228, 0
    v_accvgpr_write_b32 a229, 0
    v_accvgpr_write_b32 a232, 0
    v_accvgpr_write_b32 a233, 0
    v_cndmask_b32 v38, 0, v36, vcc
    v_cndmask_b32 v39, 0, v37, vcc
    v_xor_b32 v36, v36, v38
    v_xor_b32 v37, v37, v39
    v_accvgpr_write_b32 a226, v38
    v_accvgpr_write_b32 a227, v36
    v_accvgpr_write_b32 a230, v39
    v_accvgpr_write_b32 a231, v37
    v_mov_b32 v10, 0x3f803f80
    v_accvgpr_write_b32 a248, v10
    v_accvgpr_write_b32 a249, v10
    v_accvgpr_write_b32 a250, v10
    v_accvgpr_write_b32 a251, v10
    s_mov_b32 s22, 1
    s_mov_b32 s26, 33280
    s_mov_b32 s46, 33280
    s_mov_b32 s47, 0x5d800000
    s_mov_b64 s[44:45], 0
    s_mov_b64 s[86:87], -1
    s_getreg_b32 s30, hwreg(HW_REG_XCC_ID, 0, 1)
    s_mov_b32 s31, 0
    s_mov_b64 vcc, s[30:31]
    s_movk_i32 s97, 4096
    s_movk_i32 s98, 8192
    s_movk_i32 s99, 12288
    s_movk_i32 s100, 16384
    s_movk_i32 s101, 20480
    s_mul_i32 s30, s20, 13056
    v_bfe_u32 v10, v0, 4, 2
    v_and_b32 v11, 15, v0
    v_mul_u32_u24 v60, 272, v11
    v_lshl_add_u32 v60, v10, 4, v60
    v_add_u32 v60, s30, v60
    v_mul_u32_u24 v61, 272, v10
    v_lshl_add_u32 v61, v11, 4, v61
    v_add_u32 v61, s30, v61
    s_mul_i32 s30, s20, 24576
    v_and_b32 v62, 63, v0
    v_lshlrev_b32 v62, 4, v62
    v_add_u32 v62, s30, v62
    v_lshlrev_b32 v63, 8, v11
    v_lshl_add_u32 v63, v10, 4, v63
    v_add_u32 v63, s30, v63
    s_waitcnt vmcnt(8)
    ds_read_b128 a[0:3], v252 offset:0
    ds_read_b128 a[4:7], v253 offset:0
    ds_read_b128 a[8:11], v254 offset:0
    ds_read_b128 a[12:15], v255 offset:0
    s_waitcnt lgkmcnt(0)
    v_mfma_f32_16x16x32_bf16 v[224:227], a[226:229], a[0:3], 0
    v_mfma_f32_16x16x32_bf16 v[228:231], a[224:227], a[0:3], 0
    v_mfma_f32_16x16x32_bf16 v[224:227], a[230:233], a[0:3], v[224:227]
    s_nop 1
    v_mfma_f32_16x16x32_bf16 v[228:231], a[228:231], a[0:3], v[228:231]
    s_nop 1
    v_mfma_f32_16x16x32_bf16 v[232:235], a[226:229], a[4:7], 0
    s_nop 1
    v_cvt_pk_bf16_f32 v224, v224, v225
    v_mfma_f32_16x16x32_bf16 v[240:243], a[226:229], a[8:11], 0
    v_cvt_pk_bf16_f32 v225, v226, v227
    v_cvt_pk_bf16_f32 v226, v228, v229
    v_mfma_f32_16x16x32_bf16 v[236:239], a[224:227], a[4:7], 0
    v_cvt_pk_bf16_f32 v227, v230, v231
    v_accvgpr_write_b32 a0, v224
    v_mfma_f32_16x16x32_bf16 v[244:247], a[224:227], a[8:11], 0
    v_accvgpr_write_b32 a1, v225
    v_accvgpr_write_b32 a2, v226
    v_mfma_f32_16x16x32_bf16 v[228:231], a[224:227], a[12:15], 0
    v_accvgpr_write_b32 a3, v227
    v_mfma_f32_16x16x32_bf16 v[224:227], a[226:229], a[12:15], 0
    v_mfma_f32_16x16x32_bf16 v[232:235], a[230:233], a[4:7], v[232:235]
    s_nop 1
    v_mfma_f32_16x16x32_bf16 v[240:243], a[230:233], a[8:11], v[240:243]
    s_nop 1
    v_mfma_f32_16x16x32_bf16 v[224:227], a[230:233], a[12:15], v[224:227]
    s_nop 1
    v_mfma_f32_16x16x32_bf16 v[236:239], a[228:231], a[4:7], v[236:239]
    v_cvt_pk_bf16_f32 v232, v232, v233
    v_cvt_pk_bf16_f32 v233, v234, v235
    v_mfma_f32_16x16x32_bf16 v[244:247], a[228:231], a[8:11], v[244:247]
    v_cvt_pk_bf16_f32 v240, v240, v241
    v_cvt_pk_bf16_f32 v241, v242, v243
    v_mfma_f32_16x16x32_bf16 v[228:231], a[228:231], a[12:15], v[228:231]
    v_cvt_pk_bf16_f32 v224, v224, v225
    v_cvt_pk_bf16_f32 v225, v226, v227
    v_cvt_pk_bf16_f32 v234, v236, v237
    v_cvt_pk_bf16_f32 v235, v238, v239
    v_accvgpr_write_b32 a4, v232
    v_accvgpr_write_b32 a5, v233
    v_cvt_pk_bf16_f32 v242, v244, v245
    v_cvt_pk_bf16_f32 v243, v246, v247
    v_accvgpr_write_b32 a6, v234
    v_accvgpr_write_b32 a7, v235
    v_cvt_pk_bf16_f32 v226, v228, v229
    v_cvt_pk_bf16_f32 v227, v230, v231
    v_accvgpr_write_b32 a8, v240
    v_accvgpr_write_b32 a9, v241
    v_accvgpr_write_b32 a10, v242
    v_accvgpr_write_b32 a11, v243
    v_accvgpr_write_b32 a12, v224
    v_accvgpr_write_b32 a13, v225
    v_accvgpr_write_b32 a14, v226
    v_accvgpr_write_b32 a15, v227
    s_waitcnt vmcnt(4)
    s_barrier
    ds_read_b128 a[96:99], v2 offset:0
    ds_read_b128 a[100:103], v2 offset:64
    ds_read_b128 a[104:107], v2 offset:128
    ds_read_b128 a[108:111], v2 offset:192
    ds_read_b128 a[112:115], v2 offset:512
    ds_read_b128 a[116:119], v2 offset:576
    ds_read_b128 a[120:123], v2 offset:640
    ds_read_b128 a[124:127], v2 offset:704
    s_add_u32 m0, s33, 4096
    s_movk_i32 s34, 4096
    buffer_load_dwordx4 v248, s[4:7], s34 offen offset:0 nt lds
    buffer_load_dwordx4 v249, s[4:7], s34 offen offset:1024 nt lds
    ds_read_b64_tr_b16 a[160:161], v3 offset:0
    ds_read_b64_tr_b16 a[162:163], v3 offset:512
    ds_read_b64_tr_b16 a[164:165], v3 offset:8
    ds_read_b64_tr_b16 a[166:167], v3 offset:520
    ds_read_b64_tr_b16 a[168:169], v3 offset:64
    ds_read_b64_tr_b16 a[170:171], v3 offset:576
    ds_read_b64_tr_b16 a[172:173], v3 offset:72
    ds_read_b64_tr_b16 a[174:175], v3 offset:584
    ds_read_b64_tr_b16 a[176:177], v3 offset:128
    ds_read_b64_tr_b16 a[178:179], v3 offset:640
    ds_read_b64_tr_b16 a[180:181], v3 offset:136
    ds_read_b64_tr_b16 a[182:183], v3 offset:648
    ds_read_b64_tr_b16 a[184:185], v3 offset:192
    ds_read_b64_tr_b16 a[186:187], v3 offset:704
    ds_read_b64_tr_b16 a[188:189], v3 offset:200
    ds_read_b64_tr_b16 a[190:191], v3 offset:712
    s_waitcnt lgkmcnt(15)
    s_waitcnt lgkmcnt(12)
    v_mfma_f32_16x16x32_bf16 v[52:55], a[96:99], a[0:3], 0
    v_mfma_f32_16x16x32_bf16 v[52:55], a[100:103], a[4:7], v[52:55]
    v_mfma_f32_16x16x32_bf16 v[52:55], a[104:107], a[8:11], v[52:55]
    v_mfma_f32_16x16x32_bf16 v[52:55], a[108:111], a[12:15], v[52:55]
    s_nop 7
    v_max3_f32 v10, v52, v53, v54
    v_max_f32 v10, v10, v55
    v_mov_b32 v11, v10
    s_nop 1
    v_permlane32_swap_b32 v11, v10
    v_max_f32 v10, v10, v11
    v_mov_b32 v11, v10
    s_nop 1
    v_permlane16_swap_b32 v11, v10
    v_max_f32 v10, v10, v11
    v_sub_f32 v12, 0, v10
    v_sub_f32 v13, 0, v10
    v_sub_f32 v14, 0, v10
    v_sub_f32 v15, 0, v10
    s_nop 1
    v_mfma_f32_16x16x32_bf16 v[36:39], a[96:99], a[0:3], v[12:15]
    v_mfma_f32_16x16x32_bf16 v[36:39], a[100:103], a[4:7], v[36:39]
    v_mfma_f32_16x16x32_bf16 v[36:39], a[104:107], a[8:11], v[36:39]
    v_mfma_f32_16x16x32_bf16 v[36:39], a[108:111], a[12:15], v[36:39]
    s_nop 1
    v_mfma_f32_16x16x32_bf16 v[40:43], a[112:115], a[0:3], v[12:15]
    s_nop 1
    v_mfma_f32_16x16x32_bf16 v[40:43], a[116:119], a[4:7], v[40:43]
    s_nop 1
    v_mfma_f32_16x16x32_bf16 v[40:43], a[120:123], a[8:11], v[40:43]
    v_exp_f32 v36, v36
    v_mfma_f32_16x16x32_bf16 v[40:43], a[124:127], a[12:15], v[40:43]
    v_exp_f32 v37, v37
    v_exp_f32 v38, v38
    v_exp_f32 v39, v39
    v_add_f32 v4, v36, v37
    v_add_f32 v4, v4, v38
    v_add_f32 v4, v4, v39
    v_cvt_pk_bf16_f32 v36, v36, v37
    v_cvt_pk_bf16_f32 v37, v38, v39
    v_exp_f32 v40, v40
    v_exp_f32 v41, v41
    v_exp_f32 v42, v42
    v_exp_f32 v43, v43
    v_add_f32 v4, v4, v40
    v_add_f32 v4, v4, v41
    v_add_f32 v4, v4, v42
    v_cvt_pk_bf16_f32 v38, v40, v41
    v_add_f32 v4, v4, v43
    v_cvt_pk_bf16_f32 v39, v42, v43
    s_waitcnt vmcnt(4)
    buffer_load_dwordx4 v250, s[4:7], s34 offen offset:2048 nt lds
    buffer_load_dwordx4 v251, s[4:7], s34 offen offset:3072 nt lds
    s_waitcnt vmcnt(4)
    s_barrier
    ds_read_b128 a[128:131], v2 offset:16640
    ds_read_b128 a[132:135], v2 offset:16704
    ds_read_b128 a[136:139], v2 offset:16768
    ds_read_b128 a[140:143], v2 offset:16832
    ds_read_b128 a[144:147], v2 offset:17152
    ds_read_b128 a[148:151], v2 offset:17216
    ds_read_b128 a[152:155], v2 offset:17280
    ds_read_b128 a[156:159], v2 offset:17344
    s_add_u32 m0, s33, 8192
    s_movk_i32 s34, 8192
    buffer_load_dwordx4 v248, s[4:7], s34 offen offset:0 nt lds
    buffer_load_dwordx4 v249, s[4:7], s34 offen offset:1024 nt lds
    ds_read_b64_tr_b16 a[192:193], v3 offset:16640
    ds_read_b64_tr_b16 a[194:195], v3 offset:17152
    ds_read_b64_tr_b16 a[196:197], v3 offset:16648
    ds_read_b64_tr_b16 a[198:199], v3 offset:17160
    ds_read_b64_tr_b16 a[200:201], v3 offset:16704
    ds_read_b64_tr_b16 a[202:203], v3 offset:17216
    s_waitcnt lgkmcnt(6)
    v_mfma_f32_16x16x32_bf16 v[44:47], a[128:131], a[0:3], v[12:15]
    ds_read_b64_tr_b16 a[204:205], v3 offset:16712
    v_mfma_f32_16x16x32_bf16 v[44:47], a[132:135], a[4:7], v[44:47]
    ds_read_b64_tr_b16 a[206:207], v3 offset:17224
    v_mfma_f32_16x16x32_bf16 v[44:47], a[136:139], a[8:11], v[44:47]
    ds_read_b64_tr_b16 a[208:209], v3 offset:16768
    v_mfma_f32_16x16x32_bf16 v[44:47], a[140:143], a[12:15], v[44:47]
    ds_read_b64_tr_b16 a[210:211], v3 offset:17280
    ds_read_b64_tr_b16 a[212:213], v3 offset:16776
    v_mfma_f32_16x16x32_bf16 v[48:51], a[144:147], a[0:3], v[12:15]
    ds_read_b64_tr_b16 a[214:215], v3 offset:17288
    v_mfma_f32_16x16x32_bf16 v[48:51], a[148:151], a[4:7], v[48:51]
    ds_read_b64_tr_b16 a[216:217], v3 offset:16832
    v_mfma_f32_16x16x32_bf16 v[48:51], a[152:155], a[8:11], v[48:51]
    ds_read_b64_tr_b16 a[218:219], v3 offset:17344
    v_mfma_f32_16x16x32_bf16 v[48:51], a[156:159], a[12:15], v[48:51]
    ds_read_b64_tr_b16 a[220:221], v3 offset:16840
    ds_read_b64_tr_b16 a[222:223], v3 offset:17352
    v_add_u32 v2, 33280, v2
    v_add_u32 v3, 33280, v3
    buffer_load_dwordx4 v250, s[4:7], s34 offen offset:2048 nt lds
    buffer_load_dwordx4 v251, s[4:7], s34 offen offset:3072 nt lds
    s_waitcnt lgkmcnt(0)
    v_mfma_f32_16x16x32_bf16 v[64:67], a[160:163], v[36:39], 0
    v_exp_f32 v44, v44
    v_mfma_f32_16x16x32_bf16 v[68:71], a[164:167], v[36:39], 0
    v_exp_f32 v45, v45
    v_mfma_f32_16x16x32_bf16 v[72:75], a[168:171], v[36:39], 0
    v_exp_f32 v46, v46
    v_mfma_f32_16x16x32_bf16 v[76:79], a[172:175], v[36:39], 0
    v_exp_f32 v47, v47
    v_mfma_f32_16x16x32_bf16 v[80:83], a[176:179], v[36:39], 0
    v_add_f32 v4, v4, v44
    v_add_f32 v4, v4, v45
    v_mfma_f32_16x16x32_bf16 v[84:87], a[180:183], v[36:39], 0
    v_exp_f32 v48, v48
    v_mfma_f32_16x16x32_bf16 v[88:91], a[184:187], v[36:39], 0
    v_exp_f32 v49, v49
    v_mfma_f32_16x16x32_bf16 v[92:95], a[188:191], v[36:39], 0
    v_exp_f32 v50, v50
    v_exp_f32 v51, v51
    v_cvt_pk_bf16_f32 v44, v44, v45
    v_add_f32 v4, v4, v46
    v_add_f32 v4, v4, v47
    v_cvt_pk_bf16_f32 v45, v46, v47
    v_cvt_pk_bf16_f32 v46, v48, v49
    v_cvt_pk_bf16_f32 v47, v50, v51
    v_add_f32 v4, v4, v48
    v_add_f32 v4, v4, v49
    v_mfma_f32_16x16x32_bf16 v[64:67], a[192:195], v[44:47], v[64:67]
    v_add_f32 v4, v4, v50
    v_add_f32 v4, v4, v51
    v_mfma_f32_16x16x32_bf16 v[68:71], a[196:199], v[44:47], v[68:71]
    v_mfma_f32_16x16x32_bf16 v[72:75], a[200:203], v[44:47], v[72:75]
    v_mfma_f32_16x16x32_bf16 v[76:79], a[204:207], v[44:47], v[76:79]
    v_mfma_f32_16x16x32_bf16 v[80:83], a[208:211], v[44:47], v[80:83]
    v_mfma_f32_16x16x32_bf16 v[84:87], a[212:215], v[44:47], v[84:87]
    v_mfma_f32_16x16x32_bf16 v[88:91], a[216:219], v[44:47], v[88:91]
    v_mfma_f32_16x16x32_bf16 v[92:95], a[220:223], v[44:47], v[92:95]
    s_waitcnt vmcnt(4)
    ds_read_b128 a[16:19], v252 offset:4096
    ds_read_b128 a[20:23], v253 offset:4096
    ds_read_b128 a[24:27], v254 offset:4096
    ds_read_b128 a[28:31], v255 offset:4096
    s_add_u32 m0, s33, 12288
    s_movk_i32 s34, 12288
    buffer_load_dwordx4 v248, s[4:7], s34 offen offset:0 nt lds
    s_waitcnt lgkmcnt(0)
    v_mfma_f32_16x16x32_bf16 v[224:227], a[226:229], a[16:19], 0
    buffer_load_dwordx4 v249, s[4:7], s34 offen offset:1024 nt lds
    v_mfma_f32_16x16x32_bf16 v[228:231], a[224:227], a[16:19], 0
    v_mfma_f32_16x16x32_bf16 v[224:227], a[230:233], a[16:19], v[224:227]
    s_nop 1
    v_mfma_f32_16x16x32_bf16 v[228:231], a[228:231], a[16:19], v[228:231]
    s_nop 1
    v_mfma_f32_16x16x32_bf16 v[232:235], a[226:229], a[20:23], 0
    s_nop 1
    v_mfma_f32_16x16x32_bf16 v[236:239], a[224:227], a[20:23], 0
    v_cvt_pk_bf16_f32 v224, v224, v225
    v_cvt_pk_bf16_f32 v225, v226, v227
    v_mfma_f32_16x16x32_bf16 v[232:235], a[230:233], a[20:23], v[232:235]
    v_cvt_pk_bf16_f32 v226, v228, v229
    v_cvt_pk_bf16_f32 v227, v230, v231
    v_mfma_f32_16x16x32_bf16 v[240:243], a[226:229], a[24:27], 0
    v_accvgpr_write_b32 a16, v224
    v_accvgpr_write_b32 a17, v225
    v_mfma_f32_16x16x32_bf16 v[236:239], a[228:231], a[20:23], v[236:239]
    v_accvgpr_write_b32 a18, v226
    v_accvgpr_write_b32 a19, v227
    v_mfma_f32_16x16x32_bf16 v[244:247], a[224:227], a[24:27], 0
    v_cvt_pk_bf16_f32 v232, v232, v233
    v_cvt_pk_bf16_f32 v233, v234, v235
    v_mfma_f32_16x16x32_bf16 v[240:243], a[230:233], a[24:27], v[240:243]
    v_accvgpr_write_b32 a20, v232
    v_accvgpr_write_b32 a21, v233
    v_mfma_f32_16x16x32_bf16 v[224:227], a[226:229], a[28:31], 0
    v_cvt_pk_bf16_f32 v234, v236, v237
    v_cvt_pk_bf16_f32 v235, v238, v239
    v_mfma_f32_16x16x32_bf16 v[244:247], a[228:231], a[24:27], v[244:247]
    v_accvgpr_write_b32 a22, v234
    v_accvgpr_write_b32 a23, v235
    v_mfma_f32_16x16x32_bf16 v[228:231], a[224:227], a[28:31], 0
    v_cvt_pk_bf16_f32 v240, v240, v241
    v_cvt_pk_bf16_f32 v241, v242, v243
    v_mfma_f32_16x16x32_bf16 v[224:227], a[230:233], a[28:31], v[224:227]
    v_accvgpr_write_b32 a24, v240
    v_accvgpr_write_b32 a25, v241
    v_mfma_f32_16x16x32_bf16 v[228:231], a[228:231], a[28:31], v[228:231]
    v_cvt_pk_bf16_f32 v242, v244, v245
    v_cvt_pk_bf16_f32 v243, v246, v247
    v_mfma_f32_16x16x32_bf16 v[52:55], a[96:99], a[16:19], 0
    v_accvgpr_write_b32 a26, v242
    v_accvgpr_write_b32 a27, v243
    v_mfma_f32_16x16x32_bf16 v[52:55], a[100:103], a[20:23], v[52:55]
    v_cvt_pk_bf16_f32 v224, v224, v225
    v_cvt_pk_bf16_f32 v225, v226, v227
    v_mfma_f32_16x16x32_bf16 v[52:55], a[104:107], a[24:27], v[52:55]
    v_cvt_pk_bf16_f32 v226, v228, v229
    v_cvt_pk_bf16_f32 v227, v230, v231
    v_accvgpr_write_b32 a28, v224
    v_accvgpr_write_b32 a29, v225
    v_accvgpr_write_b32 a30, v226
    v_accvgpr_write_b32 a31, v227
    s_nop 1
    v_mfma_f32_16x16x32_bf16 v[52:55], a[108:111], a[28:31], v[52:55]
    s_nop 7
    v_max3_f32 v10, v52, v53, v54
    v_max_f32 v10, v10, v55
    v_mov_b32 v11, v10
    s_nop 1
    v_permlane32_swap_b32 v11, v10
    v_max_f32 v10, v10, v11
    v_mov_b32 v11, v10
    s_nop 1
    v_permlane16_swap_b32 v11, v10
    v_max_f32 v10, v10, v11
    v_sub_f32 v16, 0, v10
    v_sub_f32 v17, 0, v10
    v_sub_f32 v18, 0, v10
    v_sub_f32 v19, 0, v10
    s_nop 1
    v_mfma_f32_16x16x32_bf16 v[36:39], a[96:99], a[16:19], v[16:19]
    v_mfma_f32_16x16x32_bf16 v[36:39], a[100:103], a[20:23], v[36:39]
    v_mfma_f32_16x16x32_bf16 v[36:39], a[104:107], a[24:27], v[36:39]
    v_mfma_f32_16x16x32_bf16 v[36:39], a[108:111], a[28:31], v[36:39]
    buffer_load_dwordx4 v250, s[4:7], s34 offen offset:2048 nt lds
    v_mfma_f32_16x16x32_bf16 v[40:43], a[112:115], a[16:19], v[16:19]
    buffer_load_dwordx4 v251, s[4:7], s34 offen offset:3072 nt lds
    v_mfma_f32_16x16x32_bf16 v[40:43], a[116:119], a[20:23], v[40:43]
    s_nop 1
    v_mfma_f32_16x16x32_bf16 v[40:43], a[120:123], a[24:27], v[40:43]
    s_nop 0
    v_exp_f32 v36, v36
    v_mfma_f32_16x16x32_bf16 v[40:43], a[124:127], a[28:31], v[40:43]
    v_exp_f32 v37, v37
    v_mfma_f32_16x16x32_bf16 v[44:47], a[128:131], a[16:19], v[16:19]
    v_exp_f32 v38, v38
    v_mfma_f32_16x16x32_bf16 v[44:47], a[132:135], a[20:23], v[44:47]
    v_exp_f32 v39, v39
    v_mfma_f32_16x16x32_bf16 v[44:47], a[136:139], a[24:27], v[44:47]
    v_add_f32 v5, v36, v37
    v_add_f32 v5, v5, v38
    v_mfma_f32_16x16x32_bf16 v[44:47], a[140:143], a[28:31], v[44:47]
    v_exp_f32 v40, v40
    v_mfma_f32_16x16x32_bf16 v[48:51], a[144:147], a[16:19], v[16:19]
    v_exp_f32 v41, v41
    v_mfma_f32_16x16x32_bf16 v[48:51], a[148:151], a[20:23], v[48:51]
    v_exp_f32 v42, v42
    v_mfma_f32_16x16x32_bf16 v[48:51], a[152:155], a[24:27], v[48:51]
    v_add_f32 v5, v5, v39
    v_add_f32 v5, v5, v40
    v_mfma_f32_16x16x32_bf16 v[48:51], a[156:159], a[28:31], v[48:51]
    v_exp_f32 v43, v43
    v_cvt_pk_bf16_f32 v36, v36, v37
    v_add_f32 v5, v5, v41
    v_cvt_pk_bf16_f32 v37, v38, v39
    v_add_f32 v5, v5, v42
    v_cvt_pk_bf16_f32 v38, v40, v41
    v_add_f32 v5, v5, v43
    v_cvt_pk_bf16_f32 v39, v42, v43
    s_waitcnt vmcnt(4)
    s_cbranch_vccz L_thr0
L_thrb0:
    ds_read_b128 a[32:35], v252 offset:8192
    ds_read_b128 a[36:39], v253 offset:8192
    ds_read_b128 a[40:43], v254 offset:8192
    ds_read_b128 a[44:47], v255 offset:8192
    v_mfma_f32_16x16x32_bf16 v[96:99], a[160:163], v[36:39], 0
    s_add_u32 m0, s33, 0
    s_movk_i32 s34, 16384
    buffer_load_dwordx4 v248, s[4:7], s34 offen offset:0 nt lds
    v_mfma_f32_16x16x32_bf16 v[100:103], a[164:167], v[36:39], 0
    buffer_load_dwordx4 v249, s[4:7], s34 offen offset:1024 nt lds
    v_mfma_f32_16x16x32_bf16 v[104:107], a[168:171], v[36:39], 0
    v_exp_f32 v44, v44
    v_mfma_f32_16x16x32_bf16 v[108:111], a[172:175], v[36:39], 0
    v_exp_f32 v45, v45
    v_mfma_f32_16x16x32_bf16 v[112:115], a[176:179], v[36:39], 0
    v_exp_f32 v46, v46
    v_mfma_f32_16x16x32_bf16 v[116:119], a[180:183], v[36:39], 0
    v_exp_f32 v47, v47
    v_mfma_f32_16x16x32_bf16 v[120:123], a[184:187], v[36:39], 0
    v_add_f32 v5, v5, v44
    v_add_f32 v5, v5, v45
    s_waitcnt lgkmcnt(0)
    v_mfma_f32_16x16x32_bf16 v[224:227], a[226:229], a[32:35], 0
    v_exp_f32 v48, v48
    v_mfma_f32_16x16x32_bf16 v[228:231], a[224:227], a[32:35], 0
    v_exp_f32 v49, v49
    v_mfma_f32_16x16x32_bf16 v[224:227], a[230:233], a[32:35], v[224:227]
    v_exp_f32 v50, v50
    v_mfma_f32_16x16x32_bf16 v[228:231], a[228:231], a[32:35], v[228:231]
    v_exp_f32 v51, v51
    v_mfma_f32_16x16x32_bf16 v[232:235], a[226:229], a[36:39], 0
    v_cvt_pk_bf16_f32 v44, v44, v45
    v_add_f32 v5, v5, v46
    v_mfma_f32_16x16x32_bf16 v[236:239], a[224:227], a[36:39], 0
    v_add_f32 v5, v5, v47
    v_cvt_pk_bf16_f32 v224, v224, v225
    v_mfma_f32_16x16x32_bf16 v[232:235], a[230:233], a[36:39], v[232:235]
    v_cvt_pk_bf16_f32 v225, v226, v227
    v_cvt_pk_bf16_f32 v226, v228, v229
    v_mfma_f32_16x16x32_bf16 v[240:243], a[226:229], a[40:43], 0
    v_cvt_pk_bf16_f32 v227, v230, v231
    v_accvgpr_write_b32 a32, v224
    v_mfma_f32_16x16x32_bf16 v[236:239], a[228:231], a[36:39], v[236:239]
    v_accvgpr_write_b32 a33, v225
    v_accvgpr_write_b32 a34, v226
    v_mfma_f32_16x16x32_bf16 v[244:247], a[224:227], a[40:43], 0
    v_accvgpr_write_b32 a35, v227
    v_cvt_pk_bf16_f32 v232, v232, v233
    v_mfma_f32_16x16x32_bf16 v[240:243], a[230:233], a[40:43], v[240:243]
    v_cvt_pk_bf16_f32 v233, v234, v235
    v_accvgpr_write_b32 a36, v232
    v_mfma_f32_16x16x32_bf16 v[224:227], a[226:229], a[44:47], 0
    v_cvt_pk_bf16_f32 v234, v236, v237
    v_cvt_pk_bf16_f32 v235, v238, v239
    v_mfma_f32_16x16x32_bf16 v[244:247], a[228:231], a[40:43], v[244:247]
    v_accvgpr_write_b32 a37, v233
    v_accvgpr_write_b32 a38, v234
    v_mfma_f32_16x16x32_bf16 v[228:231], a[224:227], a[44:47], 0
    v_accvgpr_write_b32 a39, v235
    v_cvt_pk_bf16_f32 v240, v240, v241
    v_mfma_f32_16x16x32_bf16 v[224:227], a[230:233], a[44:47], v[224:227]
    v_cvt_pk_bf16_f32 v241, v242, v243
    v_accvgpr_write_b32 a40, v240
    v_mfma_f32_16x16x32_bf16 v[228:231], a[228:231], a[44:47], v[228:231]
    v_cvt_pk_bf16_f32 v242, v244, v245
    v_cvt_pk_bf16_f32 v243, v246, v247
    v_mfma_f32_16x16x32_bf16 v[52:55], a[96:99], a[32:35], 0
    v_accvgpr_write_b32 a41, v241
    v_accvgpr_write_b32 a42, v242
    v_mfma_f32_16x16x32_bf16 v[52:55], a[100:103], a[36:39], v[52:55]
    v_accvgpr_write_b32 a43, v243
    v_cvt_pk_bf16_f32 v224, v224, v225
    v_mfma_f32_16x16x32_bf16 v[124:127], a[188:191], v[36:39], 0
    v_cvt_pk_bf16_f32 v225, v226, v227
    v_cvt_pk_bf16_f32 v226, v228, v229
    v_mfma_f32_16x16x32_bf16 v[52:55], a[104:107], a[40:43], v[52:55]
    v_cvt_pk_bf16_f32 v227, v230, v231
    v_accvgpr_write_b32 a44, v224
    v_accvgpr_write_b32 a45, v225
    v_accvgpr_write_b32 a46, v226
    v_accvgpr_write_b32 a47, v227
    v_cvt_pk_bf16_f32 v45, v46, v47
    v_cvt_pk_bf16_f32 v46, v48, v49
    v_mfma_f32_16x16x32_bf16 v[52:55], a[108:111], a[44:47], v[52:55]
    v_cvt_pk_bf16_f32 v47, v50, v51
    v_add_f32 v5, v5, v48
    v_add_f32 v5, v5, v49
    v_mfma_f32_16x16x32_bf16 v[96:99], a[192:195], v[44:47], v[96:99]
    v_add_f32 v5, v5, v50
    v_add_f32 v5, v5, v51
    v_mfma_f32_16x16x32_bf16 v[100:103], a[196:199], v[44:47], v[100:103]
    s_nop 0
    v_max3_f32 v10, v52, v53, v54
    v_mfma_f32_16x16x32_bf16 v[104:107], a[200:203], v[44:47], v[104:107]
    v_max_f32 v10, v10, v55
    v_mov_b32 v11, v10
    v_mfma_f32_16x16x32_bf16 v[108:111], a[204:207], v[44:47], v[108:111]
    s_nop 0
    v_permlane32_swap_b32 v11, v10
    v_mfma_f32_16x16x32_bf16 v[112:115], a[208:211], v[44:47], v[112:115]
    v_max_f32 v10, v10, v11
    v_mov_b32 v11, v10
    v_mfma_f32_16x16x32_bf16 v[116:119], a[212:215], v[44:47], v[116:119]
    s_nop 0
    v_permlane16_swap_b32 v11, v10
    v_mfma_f32_16x16x32_bf16 v[120:123], a[216:219], v[44:47], v[120:123]
    v_max_f32 v10, v10, v11
    v_sub_f32 v20, 0, v10
    v_mfma_f32_16x16x32_bf16 v[124:127], a[220:223], v[44:47], v[124:127]
    v_sub_f32 v21, 0, v10
    v_sub_f32 v22, 0, v10
    v_sub_f32 v23, 0, v10
    s_nop 1
    v_mfma_f32_16x16x32_bf16 v[36:39], a[96:99], a[32:35], v[20:23]
    buffer_load_dwordx4 v250, s[4:7], s34 offen offset:2048 nt lds
    v_mfma_f32_16x16x32_bf16 v[36:39], a[100:103], a[36:39], v[36:39]
    buffer_load_dwordx4 v251, s[4:7], s34 offen offset:3072 nt lds
    v_mfma_f32_16x16x32_bf16 v[36:39], a[104:107], a[40:43], v[36:39]
    v_mfma_f32_16x16x32_bf16 v[36:39], a[108:111], a[44:47], v[36:39]
    s_nop 1
    v_mfma_f32_16x16x32_bf16 v[40:43], a[112:115], a[32:35], v[20:23]
    s_nop 1
    v_mfma_f32_16x16x32_bf16 v[40:43], a[116:119], a[36:39], v[40:43]
    s_nop 1
    v_mfma_f32_16x16x32_bf16 v[40:43], a[120:123], a[40:43], v[40:43]
    v_exp_f32 v36, v36
    v_mfma_f32_16x16x32_bf16 v[40:43], a[124:127], a[44:47], v[40:43]
    v_exp_f32 v37, v37
    v_mfma_f32_16x16x32_bf16 v[44:47], a[128:131], a[32:35], v[20:23]
    v_exp_f32 v38, v38
    v_mfma_f32_16x16x32_bf16 v[44:47], a[132:135], a[36:39], v[44:47]
    v_exp_f32 v39, v39
    v_mfma_f32_16x16x32_bf16 v[44:47], a[136:139], a[40:43], v[44:47]
    v_add_f32 v6, v36, v37
    v_add_f32 v6, v6, v38
    v_mfma_f32_16x16x32_bf16 v[44:47], a[140:143], a[44:47], v[44:47]
    v_exp_f32 v40, v40
    v_mfma_f32_16x16x32_bf16 v[48:51], a[144:147], a[32:35], v[20:23]
    v_exp_f32 v41, v41
    v_mfma_f32_16x16x32_bf16 v[48:51], a[148:151], a[36:39], v[48:51]
    v_exp_f32 v42, v42
    v_mfma_f32_16x16x32_bf16 v[48:51], a[152:155], a[40:43], v[48:51]
    v_add_f32 v6, v6, v39
    v_add_f32 v6, v6, v40
    v_mfma_f32_16x16x32_bf16 v[48:51], a[156:159], a[44:47], v[48:51]
    v_exp_f32 v43, v43
    v_cvt_pk_bf16_f32 v36, v36, v37
    v_add_f32 v6, v6, v41
    v_cvt_pk_bf16_f32 v37, v38, v39
    v_add_f32 v6, v6, v42
    v_cvt_pk_bf16_f32 v38, v40, v41
    v_add_f32 v6, v6, v43
    v_cvt_pk_bf16_f32 v39, v42, v43
    s_waitcnt vmcnt(4)
    s_cbranch_vccz L_thr1
L_thrb1:
    ds_read_b128 a[48:51], v252 offset:12288
    ds_read_b128 a[52:55], v253 offset:12288
    ds_read_b128 a[56:59], v254 offset:12288
    ds_read_b128 a[60:63], v255 offset:12288
    v_mfma_f32_16x16x32_bf16 v[128:131], a[160:163], v[36:39], 0
    s_add_u32 m0, s33, 4096
    s_movk_i32 s34, 20480
    buffer_load_dwordx4 v248, s[4:7], s34 offen offset:0 nt lds
    v_mfma_f32_16x16x32_bf16 v[132:135], a[164:167], v[36:39], 0
    buffer_load_dwordx4 v249, s[4:7], s34 offen offset:1024 nt lds
    v_mfma_f32_16x16x32_bf16 v[136:139], a[168:171], v[36:39], 0
    v_exp_f32 v44, v44
    v_mfma_f32_16x16x32_bf16 v[140:143], a[172:175], v[36:39], 0
    v_exp_f32 v45, v45
    v_mfma_f32_16x16x32_bf16 v[144:147], a[176:179], v[36:39], 0
    v_exp_f32 v46, v46
    v_mfma_f32_16x16x32_bf16 v[148:151], a[180:183], v[36:39], 0
    v_exp_f32 v47, v47
    v_mfma_f32_16x16x32_bf16 v[152:155], a[184:187], v[36:39], 0
    v_add_f32 v6, v6, v44
    v_add_f32 v6, v6, v45
    s_waitcnt lgkmcnt(0)
    v_mfma_f32_16x16x32_bf16 v[224:227], a[226:229], a[48:51], 0
    v_exp_f32 v48, v48
    v_mfma_f32_16x16x32_bf16 v[228:231], a[224:227], a[48:51], 0
    v_exp_f32 v49, v49
    v_mfma_f32_16x16x32_bf16 v[224:227], a[230:233], a[48:51], v[224:227]
    v_exp_f32 v50, v50
    v_mfma_f32_16x16x32_bf16 v[228:231], a[228:231], a[48:51], v[228:231]
    v_exp_f32 v51, v51
    v_mfma_f32_16x16x32_bf16 v[232:235], a[226:229], a[52:55], 0
    v_cvt_pk_bf16_f32 v44, v44, v45
    v_add_f32 v6, v6, v46
    v_mfma_f32_16x16x32_bf16 v[236:239], a[224:227], a[52:55], 0
    v_add_f32 v6, v6, v47
    v_cvt_pk_bf16_f32 v224, v224, v225
    v_mfma_f32_16x16x32_bf16 v[232:235], a[230:233], a[52:55], v[232:235]
    v_cvt_pk_bf16_f32 v225, v226, v227
    v_cvt_pk_bf16_f32 v226, v228, v229
    v_mfma_f32_16x16x32_bf16 v[240:243], a[226:229], a[56:59], 0
    v_cvt_pk_bf16_f32 v227, v230, v231
    v_accvgpr_write_b32 a48, v224
    v_mfma_f32_16x16x32_bf16 v[236:239], a[228:231], a[52:55], v[236:239]
    v_accvgpr_write_b32 a49, v225
    v_accvgpr_write_b32 a50, v226
    v_mfma_f32_16x16x32_bf16 v[244:247], a[224:227], a[56:59], 0
    v_accvgpr_write_b32 a51, v227
    v_cvt_pk_bf16_f32 v232, v232, v233
    v_mfma_f32_16x16x32_bf16 v[240:243], a[230:233], a[56:59], v[240:243]
    v_cvt_pk_bf16_f32 v233, v234, v235
    v_accvgpr_write_b32 a52, v232
    v_mfma_f32_16x16x32_bf16 v[224:227], a[226:229], a[60:63], 0
    v_cvt_pk_bf16_f32 v234, v236, v237
    v_cvt_pk_bf16_f32 v235, v238, v239
    v_mfma_f32_16x16x32_bf16 v[244:247], a[228:231], a[56:59], v[244:247]
    v_accvgpr_write_b32 a53, v233
    v_accvgpr_write_b32 a54, v234
    v_mfma_f32_16x16x32_bf16 v[228:231], a[224:227], a[60:63], 0
    v_accvgpr_write_b32 a55, v235
    v_cvt_pk_bf16_f32 v240, v240, v241
    v_mfma_f32_16x16x32_bf16 v[224:227], a[230:233], a[60:63], v[224:227]
    v_cvt_pk_bf16_f32 v241, v242, v243
    v_accvgpr_write_b32 a56, v240
    v_mfma_f32_16x16x32_bf16 v[228:231], a[228:231], a[60:63], v[228:231]
    v_cvt_pk_bf16_f32 v242, v244, v245
    v_cvt_pk_bf16_f32 v243, v246, v247
    v_mfma_f32_16x16x32_bf16 v[52:55], a[96:99], a[48:51], 0
    v_accvgpr_write_b32 a57, v241
    v_accvgpr_write_b32 a58, v242
    v_mfma_f32_16x16x32_bf16 v[52:55], a[100:103], a[52:55], v[52:55]
    v_accvgpr_write_b32 a59, v243
    v_cvt_pk_bf16_f32 v224, v224, v225
    v_mfma_f32_16x16x32_bf16 v[156:159], a[188:191], v[36:39], 0
    v_cvt_pk_bf16_f32 v225, v226, v227
    v_cvt_pk_bf16_f32 v226, v228, v229
    v_mfma_f32_16x16x32_bf16 v[52:55], a[104:107], a[56:59], v[52:55]
    v_cvt_pk_bf16_f32 v227, v230, v231
    v_accvgpr_write_b32 a60, v224
    v_accvgpr_write_b32 a61, v225
    v_accvgpr_write_b32 a62, v226
    v_accvgpr_write_b32 a63, v227
    v_cvt_pk_bf16_f32 v45, v46, v47
    v_cvt_pk_bf16_f32 v46, v48, v49
    v_mfma_f32_16x16x32_bf16 v[52:55], a[108:111], a[60:63], v[52:55]
    v_cvt_pk_bf16_f32 v47, v50, v51
    v_add_f32 v6, v6, v48
    v_add_f32 v6, v6, v49
    v_mfma_f32_16x16x32_bf16 v[128:131], a[192:195], v[44:47], v[128:131]
    v_add_f32 v6, v6, v50
    v_add_f32 v6, v6, v51
    v_mfma_f32_16x16x32_bf16 v[132:135], a[196:199], v[44:47], v[132:135]
    s_nop 0
    v_max3_f32 v10, v52, v53, v54
    v_mfma_f32_16x16x32_bf16 v[136:139], a[200:203], v[44:47], v[136:139]
    v_max_f32 v10, v10, v55
    v_mov_b32 v11, v10
    v_mfma_f32_16x16x32_bf16 v[140:143], a[204:207], v[44:47], v[140:143]
    s_nop 0
    v_permlane32_swap_b32 v11, v10
    v_mfma_f32_16x16x32_bf16 v[144:147], a[208:211], v[44:47], v[144:147]
    v_max_f32 v10, v10, v11
    v_mov_b32 v11, v10
    v_mfma_f32_16x16x32_bf16 v[148:151], a[212:215], v[44:47], v[148:151]
    s_nop 0
    v_permlane16_swap_b32 v11, v10
    v_mfma_f32_16x16x32_bf16 v[152:155], a[216:219], v[44:47], v[152:155]
    v_max_f32 v10, v10, v11
    v_sub_f32 v24, 0, v10
    v_mfma_f32_16x16x32_bf16 v[156:159], a[220:223], v[44:47], v[156:159]
    v_sub_f32 v25, 0, v10
    v_sub_f32 v26, 0, v10
    v_sub_f32 v27, 0, v10
    s_nop 1
    v_mfma_f32_16x16x32_bf16 v[36:39], a[96:99], a[48:51], v[24:27]
    buffer_load_dwordx4 v250, s[4:7], s34 offen offset:2048 nt lds
    v_mfma_f32_16x16x32_bf16 v[36:39], a[100:103], a[52:55], v[36:39]
    buffer_load_dwordx4 v251, s[4:7], s34 offen offset:3072 nt lds
    v_mfma_f32_16x16x32_bf16 v[36:39], a[104:107], a[56:59], v[36:39]
    v_mfma_f32_16x16x32_bf16 v[36:39], a[108:111], a[60:63], v[36:39]
    s_nop 1
    v_mfma_f32_16x16x32_bf16 v[40:43], a[112:115], a[48:51], v[24:27]
    s_nop 1
    v_mfma_f32_16x16x32_bf16 v[40:43], a[116:119], a[52:55], v[40:43]
    s_nop 1
    v_mfma_f32_16x16x32_bf16 v[40:43], a[120:123], a[56:59], v[40:43]
    v_exp_f32 v36, v36
    v_mfma_f32_16x16x32_bf16 v[40:43], a[124:127], a[60:63], v[40:43]
    v_exp_f32 v37, v37
    v_mfma_f32_16x16x32_bf16 v[44:47], a[128:131], a[48:51], v[24:27]
    v_exp_f32 v38, v38
    v_mfma_f32_16x16x32_bf16 v[44:47], a[132:135], a[52:55], v[44:47]
    v_exp_f32 v39, v39
    v_mfma_f32_16x16x32_bf16 v[44:47], a[136:139], a[56:59], v[44:47]
    v_add_f32 v7, v36, v37
    v_add_f32 v7, v7, v38
    v_mfma_f32_16x16x32_bf16 v[44:47], a[140:143], a[60:63], v[44:47]
    v_exp_f32 v40, v40
    v_mfma_f32_16x16x32_bf16 v[48:51], a[144:147], a[48:51], v[24:27]
    v_exp_f32 v41, v41
    v_mfma_f32_16x16x32_bf16 v[48:51], a[148:151], a[52:55], v[48:51]
    v_exp_f32 v42, v42
    v_mfma_f32_16x16x32_bf16 v[48:51], a[152:155], a[56:59], v[48:51]
    v_add_f32 v7, v7, v39
    v_add_f32 v7, v7, v40
    v_mfma_f32_16x16x32_bf16 v[48:51], a[156:159], a[60:63], v[48:51]
    v_exp_f32 v43, v43
    v_cvt_pk_bf16_f32 v36, v36, v37
    v_add_f32 v7, v7, v41
    v_cvt_pk_bf16_f32 v37, v38, v39
    v_add_f32 v7, v7, v42
    v_cvt_pk_bf16_f32 v38, v40, v41
    v_add_f32 v7, v7, v43
    v_cvt_pk_bf16_f32 v39, v42, v43
    s_waitcnt vmcnt(4)
    s_cbranch_vccz L_thr2
L_thrb2:
    ds_read_b128 a[64:67], v252 offset:0
    ds_read_b128 a[68:71], v253 offset:0
    ds_read_b128 a[72:75], v254 offset:0
    ds_read_b128 a[76:79], v255 offset:0
    v_mfma_f32_16x16x32_bf16 v[160:163], a[160:163], v[36:39], 0
    s_add_u32 s24, s24, 16640
    s_add_u32 s23, s23, 8192
    s_and_b32 s23, s23, 0x1ffff
    s_add_u32 s25, s23, 32
    s_add_u32 s3, s23, 8
    s_mov_b32 m0, s24
    s_nop 0
    buffer_load_dwordx4 v1, s[8:11], s25 offen nt lds
    v_mfma_f32_16x16x32_bf16 v[164:167], a[164:167], v[36:39], 0
    buffer_load_dwordx4 v1, s[8:11], s23 offen offset:1056 nt lds
    v_mfma_f32_16x16x32_bf16 v[168:171], a[168:171], v[36:39], 0
    v_exp_f32 v44, v44
    v_mfma_f32_16x16x32_bf16 v[172:175], a[172:175], v[36:39], 0
    v_exp_f32 v45, v45
    v_mfma_f32_16x16x32_bf16 v[176:179], a[176:179], v[36:39], 0
    v_exp_f32 v46, v46
    v_mfma_f32_16x16x32_bf16 v[180:183], a[180:183], v[36:39], 0
    v_exp_f32 v47, v47
    v_mfma_f32_16x16x32_bf16 v[184:187], a[184:187], v[36:39], 0
    v_add_f32 v7, v7, v44
    v_add_f32 v7, v7, v45
    s_waitcnt lgkmcnt(0)
    v_mfma_f32_16x16x32_bf16 v[224:227], a[226:229], a[64:67], 0
    v_exp_f32 v48, v48
    v_mfma_f32_16x16x32_bf16 v[228:231], a[224:227], a[64:67], 0
    v_exp_f32 v49, v49
    v_mfma_f32_16x16x32_bf16 v[224:227], a[230:233], a[64:67], v[224:227]
    v_exp_f32 v50, v50
    v_mfma_f32_16x16x32_bf16 v[228:231], a[228:231], a[64:67], v[228:231]
    v_exp_f32 v51, v51
    v_mfma_f32_16x16x32_bf16 v[232:235], a[226:229], a[68:71], 0
    v_cvt_pk_bf16_f32 v44, v44, v45
    v_add_f32 v7, v7, v46
    v_mfma_f32_16x16x32_bf16 v[236:239], a[224:227], a[68:71], 0
    v_add_f32 v7, v7, v47
    v_cvt_pk_bf16_f32 v224, v224, v225
    v_mfma_f32_16x16x32_bf16 v[232:235], a[230:233], a[68:71], v[232:235]
    v_cvt_pk_bf16_f32 v225, v226, v227
    v_cvt_pk_bf16_f32 v226, v228, v229
    v_mfma_f32_16x16x32_bf16 v[240:243], a[226:229], a[72:75], 0
    v_cvt_pk_bf16_f32 v227, v230, v231
    v_accvgpr_write_b32 a64, v224
    v_mfma_f32_16x16x32_bf16 v[236:239], a[228:231], a[68:71], v[236:239]
    v_accvgpr_write_b32 a65, v225
    v_accvgpr_write_b32 a66, v226
    v_mfma_f32_16x16x32_bf16 v[244:247], a[224:227], a[72:75], 0
    v_accvgpr_write_b32 a67, v227
    v_cvt_pk_bf16_f32 v232, v232, v233
    v_mfma_f32_16x16x32_bf16 v[240:243], a[230:233], a[72:75], v[240:243]
    v_cvt_pk_bf16_f32 v233, v234, v235
    v_accvgpr_write_b32 a68, v232
    v_mfma_f32_16x16x32_bf16 v[224:227], a[226:229], a[76:79], 0
    v_cvt_pk_bf16_f32 v234, v236, v237
    v_cvt_pk_bf16_f32 v235, v238, v239
    v_mfma_f32_16x16x32_bf16 v[244:247], a[228:231], a[72:75], v[244:247]
    v_accvgpr_write_b32 a69, v233
    v_accvgpr_write_b32 a70, v234
    v_mfma_f32_16x16x32_bf16 v[228:231], a[224:227], a[76:79], 0
    v_accvgpr_write_b32 a71, v235
    v_cvt_pk_bf16_f32 v240, v240, v241
    v_mfma_f32_16x16x32_bf16 v[224:227], a[230:233], a[76:79], v[224:227]
    v_cvt_pk_bf16_f32 v241, v242, v243
    v_accvgpr_write_b32 a72, v240
    v_mfma_f32_16x16x32_bf16 v[228:231], a[228:231], a[76:79], v[228:231]
    v_cvt_pk_bf16_f32 v242, v244, v245
    v_cvt_pk_bf16_f32 v243, v246, v247
    v_mfma_f32_16x16x32_bf16 v[52:55], a[96:99], a[64:67], 0
    v_accvgpr_write_b32 a73, v241
    v_accvgpr_write_b32 a74, v242
    v_mfma_f32_16x16x32_bf16 v[52:55], a[100:103], a[68:71], v[52:55]
    v_accvgpr_write_b32 a75, v243
    v_cvt_pk_bf16_f32 v224, v224, v225
    v_mfma_f32_16x16x32_bf16 v[188:191], a[188:191], v[36:39], 0
    v_cvt_pk_bf16_f32 v225, v226, v227
    v_cvt_pk_bf16_f32 v226, v228, v229
    v_mfma_f32_16x16x32_bf16 v[52:55], a[104:107], a[72:75], v[52:55]
    v_cvt_pk_bf16_f32 v227, v230, v231
    v_accvgpr_write_b32 a76, v224
    v_accvgpr_write_b32 a77, v225
    v_accvgpr_write_b32 a78, v226
    v_accvgpr_write_b32 a79, v227
    v_cvt_pk_bf16_f32 v45, v46, v47
    v_cvt_pk_bf16_f32 v46, v48, v49
    v_mfma_f32_16x16x32_bf16 v[52:55], a[108:111], a[76:79], v[52:55]
    v_cvt_pk_bf16_f32 v47, v50, v51
    v_add_f32 v7, v7, v48
    v_add_f32 v7, v7, v49
    v_mfma_f32_16x16x32_bf16 v[160:163], a[192:195], v[44:47], v[160:163]
    v_add_f32 v7, v7, v50
    v_add_f32 v7, v7, v51
    v_mfma_f32_16x16x32_bf16 v[164:167], a[196:199], v[44:47], v[164:167]
    s_nop 0
    v_max3_f32 v10, v52, v53, v54
    v_mfma_f32_16x16x32_bf16 v[168:171], a[200:203], v[44:47], v[168:171]
    v_max_f32 v10, v10, v55
    v_mov_b32 v11, v10
    v_mfma_f32_16x16x32_bf16 v[172:175], a[204:207], v[44:47], v[172:175]
    s_nop 0
    v_permlane32_swap_b32 v11, v10
    v_mfma_f32_16x16x32_bf16 v[176:179], a[208:211], v[44:47], v[176:179]
    v_max_f32 v10, v10, v11
    v_mov_b32 v11, v10
    v_mfma_f32_16x16x32_bf16 v[180:183], a[212:215], v[44:47], v[180:183]
    s_nop 0
    v_permlane16_swap_b32 v11, v10
    v_mfma_f32_16x16x32_bf16 v[184:187], a[216:219], v[44:47], v[184:187]
    v_max_f32 v10, v10, v11
    v_sub_f32 v28, 0, v10
    v_mfma_f32_16x16x32_bf16 v[188:191], a[220:223], v[44:47], v[188:191]
    v_sub_f32 v29, 0, v10
    v_sub_f32 v30, 0, v10
    v_sub_f32 v31, 0, v10
    buffer_load_dwordx4 v1, s[12:15], s3 offen offset:2080 nt lds
    s_nop 0
    v_mfma_f32_16x16x32_bf16 v[36:39], a[96:99], a[64:67], v[28:31]
    buffer_load_dwordx4 v1, s[12:15], s23 offen offset:3112 nt lds
    v_mfma_f32_16x16x32_bf16 v[36:39], a[100:103], a[68:71], v[36:39]
    v_mfma_f32_16x16x32_bf16 v[36:39], a[104:107], a[72:75], v[36:39]
    v_mfma_f32_16x16x32_bf16 v[36:39], a[108:111], a[76:79], v[36:39]
    s_nop 1
    v_mfma_f32_16x16x32_bf16 v[40:43], a[112:115], a[64:67], v[28:31]
    s_nop 1
    v_mfma_f32_16x16x32_bf16 v[40:43], a[116:119], a[68:71], v[40:43]
    s_nop 1
    v_mfma_f32_16x16x32_bf16 v[40:43], a[120:123], a[72:75], v[40:43]
    v_exp_f32 v36, v36
    v_mfma_f32_16x16x32_bf16 v[40:43], a[124:127], a[76:79], v[40:43]
    v_exp_f32 v37, v37
    v_mfma_f32_16x16x32_bf16 v[44:47], a[128:131], a[64:67], v[28:31]
    v_exp_f32 v38, v38
    v_mfma_f32_16x16x32_bf16 v[44:47], a[132:135], a[68:71], v[44:47]
    v_exp_f32 v39, v39
    v_mfma_f32_16x16x32_bf16 v[44:47], a[136:139], a[72:75], v[44:47]
    v_add_f32 v8, v36, v37
    v_add_f32 v8, v8, v38
    v_mfma_f32_16x16x32_bf16 v[44:47], a[140:143], a[76:79], v[44:47]
    v_exp_f32 v40, v40
    v_mfma_f32_16x16x32_bf16 v[48:51], a[144:147], a[64:67], v[28:31]
    v_exp_f32 v41, v41
    v_mfma_f32_16x16x32_bf16 v[48:51], a[148:151], a[68:71], v[48:51]
    v_exp_f32 v42, v42
    v_mfma_f32_16x16x32_bf16 v[48:51], a[152:155], a[72:75], v[48:51]
    v_add_f32 v8, v8, v39
    v_add_f32 v8, v8, v40
    v_mfma_f32_16x16x32_bf16 v[48:51], a[156:159], a[76:79], v[48:51]
    v_exp_f32 v43, v43
    v_cvt_pk_bf16_f32 v36, v36, v37
    v_add_f32 v8, v8, v41
    v_cvt_pk_bf16_f32 v37, v38, v39
    v_add_f32 v8, v8, v42
    v_cvt_pk_bf16_f32 v38, v40, v41
    v_add_f32 v8, v8, v43
    v_cvt_pk_bf16_f32 v39, v42, v43
    s_cmp_eq_u32 s20, 3
    s_cbranch_scc1 L_ldr
    s_waitcnt vmcnt(4)
    ds_read_b128 a[80:83], v252 offset:4096
    ds_read_b128 a[84:87], v253 offset:4096
    ds_read_b128 a[88:91], v254 offset:4096
    ds_read_b128 a[92:95], v255 offset:4096
    v_mfma_f32_16x16x32_bf16 v[192:195], a[160:163], v[36:39], 0
    v_exp_f32 v44, v44
    v_mfma_f32_16x16x32_bf16 v[196:199], a[164:167], v[36:39], 0
    v_exp_f32 v45, v45
    v_mfma_f32_16x16x32_bf16 v[200:203], a[168:171], v[36:39], 0
    v_exp_f32 v46, v46
    v_mfma_f32_16x16x32_bf16 v[204:207], a[172:175], v[36:39], 0
    v_exp_f32 v47, v47
    v_mfma_f32_16x16x32_bf16 v[208:211], a[176:179], v[36:39], 0
    v_add_f32 v8, v8, v44
    v_add_f32 v8, v8, v45
    v_mfma_f32_16x16x32_bf16 v[212:215], a[180:183], v[36:39], 0
    v_exp_f32 v48, v48
    v_mfma_f32_16x16x32_bf16 v[216:219], a[184:187], v[36:39], 0
    v_exp_f32 v49, v49
    v_mfma_f32_16x16x32_bf16 v[220:223], a[188:191], v[36:39], 0
    v_add_f32 v8, v8, v46
    v_add_f32 v8, v8, v47
    s_waitcnt lgkmcnt(0)
    v_mfma_f32_16x16x32_bf16 v[224:227], a[226:229], a[80:83], 0
    v_exp_f32 v50, v50
    v_mfma_f32_16x16x32_bf16 v[228:231], a[224:227], a[80:83], 0
    v_exp_f32 v51, v51
    v_mfma_f32_16x16x32_bf16 v[224:227], a[230:233], a[80:83], v[224:227]
    v_add_f32 v8, v8, v48
    v_cvt_pk_bf16_f32 v44, v44, v45
    v_mfma_f32_16x16x32_bf16 v[228:231], a[228:231], a[80:83], v[228:231]
    v_add_f32 v8, v8, v49
    v_cvt_pk_bf16_f32 v45, v46, v47
    v_mfma_f32_16x16x32_bf16 v[232:235], a[226:229], a[84:87], 0
    v_add_f32 v8, v8, v50
    v_cvt_pk_bf16_f32 v46, v48, v49
    v_mfma_f32_16x16x32_bf16 v[236:239], a[224:227], a[84:87], 0
    v_cvt_pk_bf16_f32 v224, v224, v225
    v_cvt_pk_bf16_f32 v225, v226, v227
    v_mfma_f32_16x16x32_bf16 v[232:235], a[230:233], a[84:87], v[232:235]
    v_cvt_pk_bf16_f32 v226, v228, v229
    v_cvt_pk_bf16_f32 v227, v230, v231
    v_mfma_f32_16x16x32_bf16 v[240:243], a[226:229], a[88:91], 0
    v_accvgpr_write_b32 a80, v224
    v_accvgpr_write_b32 a81, v225
    v_mfma_f32_16x16x32_bf16 v[236:239], a[228:231], a[84:87], v[236:239]
    v_accvgpr_write_b32 a82, v226
    v_accvgpr_write_b32 a83, v227
    v_mfma_f32_16x16x32_bf16 v[244:247], a[224:227], a[88:91], 0
    v_cvt_pk_bf16_f32 v232, v232, v233
    v_cvt_pk_bf16_f32 v233, v234, v235
    v_mfma_f32_16x16x32_bf16 v[240:243], a[230:233], a[88:91], v[240:243]
    v_accvgpr_write_b32 a84, v232
    v_accvgpr_write_b32 a85, v233
    v_mfma_f32_16x16x32_bf16 v[224:227], a[226:229], a[92:95], 0
    v_cvt_pk_bf16_f32 v234, v236, v237
    v_cvt_pk_bf16_f32 v235, v238, v239
    v_mfma_f32_16x16x32_bf16 v[244:247], a[228:231], a[88:91], v[244:247]
    v_accvgpr_write_b32 a86, v234
    v_accvgpr_write_b32 a87, v235
    v_mfma_f32_16x16x32_bf16 v[228:231], a[224:227], a[92:95], 0
    v_cvt_pk_bf16_f32 v240, v240, v241
    v_cvt_pk_bf16_f32 v241, v242, v243
    v_mfma_f32_16x16x32_bf16 v[224:227], a[230:233], a[92:95], v[224:227]
    v_accvgpr_write_b32 a88, v240
    v_accvgpr_write_b32 a89, v241
    v_mfma_f32_16x16x32_bf16 v[228:231], a[228:231], a[92:95], v[228:231]
    v_cvt_pk_bf16_f32 v242, v244, v245
    v_cvt_pk_bf16_f32 v243, v246, v247
    v_mfma_f32_16x16x32_bf16 v[52:55], a[96:99], a[80:83], 0
    v_accvgpr_write_b32 a90, v242
    v_accvgpr_write_b32 a91, v243
    v_mfma_f32_16x16x32_bf16 v[52:55], a[100:103], a[84:87], v[52:55]
    v_cvt_pk_bf16_f32 v224, v224, v225
    v_cvt_pk_bf16_f32 v225, v226, v227
    v_mfma_f32_16x16x32_bf16 v[52:55], a[104:107], a[88:91], v[52:55]
    v_cvt_pk_bf16_f32 v226, v228, v229
    v_cvt_pk_bf16_f32 v227, v230, v231
    v_accvgpr_write_b32 a92, v224
    v_accvgpr_write_b32 a93, v225
    v_accvgpr_write_b32 a94, v226
    v_accvgpr_write_b32 a95, v227
    v_add_f32 v8, v8, v51
    v_cvt_pk_bf16_f32 v47, v50, v51
    v_mfma_f32_16x16x32_bf16 v[52:55], a[108:111], a[92:95], v[52:55]
    s_nop 7
    v_max3_f32 v10, v52, v53, v54
    v_max_f32 v10, v10, v55
    v_mov_b32 v11, v10
    s_nop 1
    v_permlane32_swap_b32 v11, v10
    v_max_f32 v10, v10, v11
    v_mov_b32 v11, v10
    s_nop 1
    v_permlane16_swap_b32 v11, v10
    v_max_f32 v10, v10, v11
    v_sub_f32 v32, 0, v10
    v_sub_f32 v33, 0, v10
    v_sub_f32 v34, 0, v10
    v_sub_f32 v35, 0, v10
    s_nop 1
    v_mfma_f32_16x16x32_bf16 v[36:39], a[96:99], a[80:83], v[32:35]
    v_mfma_f32_16x16x32_bf16 v[36:39], a[100:103], a[84:87], v[36:39]
    v_mfma_f32_16x16x32_bf16 v[36:39], a[104:107], a[88:91], v[36:39]
    v_mfma_f32_16x16x32_bf16 v[36:39], a[108:111], a[92:95], v[36:39]
    s_nop 1
    v_mfma_f32_16x16x32_bf16 v[40:43], a[112:115], a[80:83], v[32:35]
    s_nop 1
    v_mfma_f32_16x16x32_bf16 v[40:43], a[116:119], a[84:87], v[40:43]
    s_nop 1
    v_mfma_f32_16x16x32_bf16 v[40:43], a[120:123], a[88:91], v[40:43]
    v_exp_f32 v36, v36
    v_mfma_f32_16x16x32_bf16 v[40:43], a[124:127], a[92:95], v[40:43]
    v_exp_f32 v37, v37
    v_mfma_f32_16x16x32_bf16 v[52:55], a[128:131], a[80:83], v[32:35]
    v_exp_f32 v38, v38
    v_mfma_f32_16x16x32_bf16 v[52:55], a[132:135], a[84:87], v[52:55]
    v_exp_f32 v39, v39
    v_mfma_f32_16x16x32_bf16 v[52:55], a[136:139], a[88:91], v[52:55]
    v_add_f32 v9, v36, v37
    v_add_f32 v9, v9, v38
    v_mfma_f32_16x16x32_bf16 v[52:55], a[140:143], a[92:95], v[52:55]
    v_exp_f32 v40, v40
    v_mfma_f32_16x16x32_bf16 v[56:59], a[144:147], a[80:83], v[32:35]
    v_exp_f32 v41, v41
    v_mfma_f32_16x16x32_bf16 v[56:59], a[148:151], a[84:87], v[56:59]
    v_exp_f32 v42, v42
    v_mfma_f32_16x16x32_bf16 v[56:59], a[152:155], a[88:91], v[56:59]
    v_add_f32 v9, v9, v39
    v_add_f32 v9, v9, v40
    v_mfma_f32_16x16x32_bf16 v[56:59], a[156:159], a[92:95], v[56:59]
    v_exp_f32 v43, v43
    v_add_f32 v9, v9, v41
    v_exp_f32 v52, v52
    v_add_f32 v9, v9, v42
    v_exp_f32 v53, v53
    v_add_f32 v9, v9, v43
    v_exp_f32 v54, v54
    v_cvt_pk_bf16_f32 v36, v36, v37
    v_add_f32 v9, v9, v52
    v_cvt_pk_bf16_f32 v37, v38, v39
    v_add_f32 v9, v9, v53
    v_exp_f32 v55, v55
    v_cvt_pk_bf16_f32 v38, v40, v41
    v_cvt_pk_bf16_f32 v39, v42, v43
    v_add_f32 v9, v9, v54
    v_cvt_pk_bf16_f32 v52, v52, v53
    s_waitcnt vmcnt(0)
    s_barrier
    ds_read_b128 a[96:99], v2 offset:0
    ds_read_b128 a[100:103], v2 offset:64
    ds_read_b128 a[104:107], v2 offset:128
    ds_read_b128 a[108:111], v2 offset:192
    ds_read_b128 a[112:115], v2 offset:512
    ds_read_b128 a[116:119], v2 offset:576
    ds_read_b128 a[120:123], v2 offset:640
    ds_read_b128 a[124:127], v2 offset:704
    v_mfma_f32_16x16x32_bf16 v[224:227], a[160:163], v[36:39], 0
    ds_read_b64_tr_b16 a[160:161], v3 offset:0
    ds_read_b64_tr_b16 a[162:163], v3 offset:512
    v_mfma_f32_16x16x32_bf16 v[228:231], a[164:167], v[36:39], 0
    ds_read_b64_tr_b16 a[164:165], v3 offset:8
    ds_read_b64_tr_b16 a[166:167], v3 offset:520
    v_mfma_f32_16x16x32_bf16 v[232:235], a[168:171], v[36:39], 0
    ds_read_b64_tr_b16 a[168:169], v3 offset:64
    ds_read_b64_tr_b16 a[170:171], v3 offset:576
    v_mfma_f32_16x16x32_bf16 v[236:239], a[172:175], v[36:39], 0
    ds_read_b64_tr_b16 a[172:173], v3 offset:72
    ds_read_b64_tr_b16 a[174:175], v3 offset:584
    v_mfma_f32_16x16x32_bf16 v[240:243], a[176:179], v[36:39], 0
    v_mfma_f32_16x16x32_bf16 v[244:247], a[180:183], v[36:39], 0
    v_mfma_f32_16x16x32_bf16 v[248:251], a[184:187], v[36:39], 0
    v_mfma_f32_16x16x32_bf16 v[252:255], a[188:191], v[36:39], 0
    s_waitcnt lgkmcnt(8)
.p2align 6
L_loop:
    v_mfma_f32_16x16x32_bf16 v[36:39], a[96:99], a[0:3], v[12:15]
    v_exp_f32 v56, v56
    v_mfma_f32_16x16x32_bf16 v[36:39], a[100:103], a[4:7], v[36:39]
    ds_read_b64_tr_b16 a[176:177], v3 offset:128
    v_add_f32 v9, v9, v55
    v_mfma_f32_16x16x32_bf16 v[36:39], a[104:107], a[8:11], v[36:39]
    v_exp_f32 v57, v57
    v_mfma_f32_16x16x32_bf16 v[36:39], a[108:111], a[12:15], v[36:39]
    v_add_f32 v9, v9, v56
    v_cvt_pk_bf16_f32 v53, v54, v55
    v_mfma_f32_16x16x32_bf16 v[40:43], a[112:115], a[0:3], v[12:15]
    v_exp_f32 v58, v58
    v_mfma_f32_16x16x32_bf16 v[40:43], a[116:119], a[4:7], v[40:43]
    ds_read_b64_tr_b16 a[178:179], v3 offset:640
    v_add_f32 v9, v9, v57
    v_mfma_f32_16x16x32_bf16 v[40:43], a[120:123], a[8:11], v[40:43]
    v_exp_f32 v59, v59
    v_mfma_f32_16x16x32_bf16 v[40:43], a[124:127], a[12:15], v[40:43]
    v_add_f32 v9, v9, v58
    v_cvt_pk_bf16_f32 v54, v56, v57
    v_mfma_f32_16x16x32_bf16 v[192:195], a[192:195], v[44:47], v[192:195]
    v_exp_f32 v36, v36
    v_mfma_f32_16x16x32_bf16 v[196:199], a[196:199], v[44:47], v[196:199]
    ds_read_b64_tr_b16 a[180:181], v3 offset:136
    v_add_f32 v9, v9, v59
    v_mfma_f32_16x16x32_bf16 v[200:203], a[200:203], v[44:47], v[200:203]
    v_exp_f32 v37, v37
    v_mfma_f32_16x16x32_bf16 v[204:207], a[204:207], v[44:47], v[204:207]
    v_add_f32 v4, v4, v36
    v_cvt_pk_bf16_f32 v55, v58, v59
    v_mfma_f32_16x16x32_bf16 v[208:211], a[208:211], v[44:47], v[208:211]
    v_exp_f32 v38, v38
    v_mfma_f32_16x16x32_bf16 v[212:215], a[212:215], v[44:47], v[212:215]
    ds_read_b64_tr_b16 a[182:183], v3 offset:648
    v_add_f32 v4, v4, v37
    v_mfma_f32_16x16x32_bf16 v[216:219], a[216:219], v[44:47], v[216:219]
    v_exp_f32 v39, v39
    v_mfma_f32_16x16x32_bf16 v[220:223], a[220:223], v[44:47], v[220:223]
    v_add_f32 v4, v4, v38
    v_cvt_pk_bf16_f32 v36, v36, v37
    v_mfma_f32_16x16x32_bf16 v[44:47], a[96:99], a[16:19], v[16:19]
    v_exp_f32 v40, v40
    v_mfma_f32_16x16x32_bf16 v[44:47], a[100:103], a[20:23], v[44:47]
    ds_read_b64_tr_b16 a[184:185], v3 offset:192
    v_add_f32 v4, v4, v39
    v_mfma_f32_16x16x32_bf16 v[44:47], a[104:107], a[24:27], v[44:47]
    v_exp_f32 v41, v41
    v_mfma_f32_16x16x32_bf16 v[44:47], a[108:111], a[28:31], v[44:47]
    v_add_f32 v4, v4, v40
    v_cvt_pk_bf16_f32 v37, v38, v39
    v_mfma_f32_16x16x32_bf16 v[48:51], a[112:115], a[16:19], v[16:19]
    v_exp_f32 v42, v42
    v_mfma_f32_16x16x32_bf16 v[48:51], a[116:119], a[20:23], v[48:51]
    ds_read_b64_tr_b16 a[186:187], v3 offset:704
    v_add_f32 v4, v4, v41
    v_mfma_f32_16x16x32_bf16 v[48:51], a[120:123], a[24:27], v[48:51]
    v_exp_f32 v43, v43
    v_mfma_f32_16x16x32_bf16 v[48:51], a[124:127], a[28:31], v[48:51]
    v_add_f32 v4, v4, v42
    v_cvt_pk_bf16_f32 v38, v40, v41
    v_mfma_f32_16x16x32_bf16 v[224:227], a[192:195], v[52:55], v[224:227]
    v_exp_f32 v44, v44
    v_mfma_f32_16x16x32_bf16 v[228:231], a[196:199], v[52:55], v[228:231]
    ds_read_b64_tr_b16 a[188:189], v3 offset:200
    v_add_f32 v4, v4, v43
    v_mfma_f32_16x16x32_bf16 v[232:235], a[200:203], v[52:55], v[232:235]
    v_exp_f32 v45, v45
    v_mfma_f32_16x16x32_bf16 v[236:239], a[204:207], v[52:55], v[236:239]
    v_add_f32 v5, v5, v44
    v_cvt_pk_bf16_f32 v39, v42, v43
    v_mfma_f32_16x16x32_bf16 v[240:243], a[208:211], v[52:55], v[240:243]
    v_exp_f32 v46, v46
    v_mfma_f32_16x16x32_bf16 v[244:247], a[212:215], v[52:55], v[244:247]
    ds_read_b64_tr_b16 a[190:191], v3 offset:712
    v_add_f32 v5, v5, v45
    v_mfma_f32_16x16x32_bf16 v[248:251], a[216:219], v[52:55], v[248:251]
    s_barrier
    v_exp_f32 v47, v47
    v_mfma_f32_16x16x32_bf16 v[252:255], a[220:223], v[52:55], v[252:255]
    v_add_f32 v5, v5, v46
    v_cvt_pk_bf16_f32 v44, v44, v45
    v_mfma_f32_16x16x32_bf16 v[52:55], a[96:99], a[32:35], v[20:23]
    v_exp_f32 v48, v48
    v_mfma_f32_16x16x32_bf16 v[52:55], a[100:103], a[36:39], v[52:55]
    ds_read_b128 a[128:131], v2 offset:16640
    v_add_f32 v5, v5, v47
    v_mfma_f32_16x16x32_bf16 v[52:55], a[104:107], a[40:43], v[52:55]
    v_exp_f32 v49, v49
    v_mfma_f32_16x16x32_bf16 v[52:55], a[108:111], a[44:47], v[52:55]
    v_add_f32 v5, v5, v48
    v_cvt_pk_bf16_f32 v45, v46, v47
    v_mfma_f32_16x16x32_bf16 v[56:59], a[112:115], a[32:35], v[20:23]
    v_exp_f32 v50, v50
    v_mfma_f32_16x16x32_bf16 v[56:59], a[116:119], a[36:39], v[56:59]
    ds_read_b128 a[132:135], v2 offset:16704
    v_add_f32 v5, v5, v49
    v_mfma_f32_16x16x32_bf16 v[56:59], a[120:123], a[40:43], v[56:59]
    v_exp_f32 v51, v51
    v_mfma_f32_16x16x32_bf16 v[56:59], a[124:127], a[44:47], v[56:59]
    s_waitcnt lgkmcnt(2)
    v_add_f32 v5, v5, v50
    v_cvt_pk_bf16_f32 v46, v48, v49
    v_mfma_f32_16x16x32_bf16 v[64:67], a[160:163], v[36:39], v[64:67]
    v_exp_f32 v52, v52
    v_mfma_f32_16x16x32_bf16 v[68:71], a[164:167], v[36:39], v[68:71]
    ds_read_b128 a[136:139], v2 offset:16768
    v_add_f32 v5, v5, v51
    v_mfma_f32_16x16x32_bf16 v[72:75], a[168:171], v[36:39], v[72:75]
    v_exp_f32 v53, v53
    v_mfma_f32_16x16x32_bf16 v[76:79], a[172:175], v[36:39], v[76:79]
    v_add_f32 v6, v6, v52
    v_cvt_pk_bf16_f32 v47, v50, v51
    v_mfma_f32_16x16x32_bf16 v[80:83], a[176:179], v[36:39], v[80:83]
    v_exp_f32 v54, v54
    v_mfma_f32_16x16x32_bf16 v[84:87], a[180:183], v[36:39], v[84:87]
    ds_read_b128 a[140:143], v2 offset:16832
    v_add_f32 v6, v6, v53
    v_mfma_f32_16x16x32_bf16 v[88:91], a[184:187], v[36:39], v[88:91]
    v_exp_f32 v55, v55
    v_mfma_f32_16x16x32_bf16 v[92:95], a[188:191], v[36:39], v[92:95]
    v_add_f32 v6, v6, v54
    v_cvt_pk_bf16_f32 v52, v52, v53
    v_mfma_f32_16x16x32_bf16 v[36:39], a[96:99], a[48:51], v[24:27]
    v_exp_f32 v56, v56
    v_mfma_f32_16x16x32_bf16 v[36:39], a[100:103], a[52:55], v[36:39]
    ds_read_b128 a[144:147], v2 offset:17152
    v_add_f32 v6, v6, v55
    v_mfma_f32_16x16x32_bf16 v[36:39], a[104:107], a[56:59], v[36:39]
    v_exp_f32 v57, v57
    v_mfma_f32_16x16x32_bf16 v[36:39], a[108:111], a[60:63], v[36:39]
    v_add_f32 v6, v6, v56
    v_cvt_pk_bf16_f32 v53, v54, v55
    v_mfma_f32_16x16x32_bf16 v[40:43], a[112:115], a[48:51], v[24:27]
    v_exp_f32 v58, v58
    v_mfma_f32_16x16x32_bf16 v[40:43], a[116:119], a[52:55], v[40:43]
    ds_read_b128 a[148:151], v2 offset:17216
    v_add_f32 v6, v6, v57
    v_mfma_f32_16x16x32_bf16 v[40:43], a[120:123], a[56:59], v[40:43]
    v_exp_f32 v59, v59
    v_mfma_f32_16x16x32_bf16 v[40:43], a[124:127], a[60:63], v[40:43]
    v_add_f32 v6, v6, v58
    v_cvt_pk_bf16_f32 v54, v56, v57
    v_mfma_f32_16x16x32_bf16 v[96:99], a[160:163], v[44:47], v[96:99]
    v_exp_f32 v36, v36
    v_mfma_f32_16x16x32_bf16 v[100:103], a[164:167], v[44:47], v[100:103]
    ds_read_b128 a[152:155], v2 offset:17280
    v_add_f32 v6, v6, v59
    v_mfma_f32_16x16x32_bf16 v[104:107], a[168:171], v[44:47], v[104:107]
    v_exp_f32 v37, v37
    v_mfma_f32_16x16x32_bf16 v[108:111], a[172:175], v[44:47], v[108:111]
    v_add_f32 v7, v7, v36
    v_cvt_pk_bf16_f32 v55, v58, v59
    v_mfma_f32_16x16x32_bf16 v[112:115], a[176:179], v[44:47], v[112:115]
    v_exp_f32 v38, v38
    v_mfma_f32_16x16x32_bf16 v[116:119], a[180:183], v[44:47], v[116:119]
    ds_read_b128 a[156:159], v2 offset:17344
    v_add_f32 v7, v7, v37
    v_mfma_f32_16x16x32_bf16 v[120:123], a[184:187], v[44:47], v[120:123]
    v_exp_f32 v39, v39
    v_mfma_f32_16x16x32_bf16 v[124:127], a[188:191], v[44:47], v[124:127]
    v_add_f32 v7, v7, v38
    v_cvt_pk_bf16_f32 v36, v36, v37
    v_mfma_f32_16x16x32_bf16 v[44:47], a[96:99], a[64:67], v[28:31]
    v_exp_f32 v40, v40
    v_mfma_f32_16x16x32_bf16 v[44:47], a[100:103], a[68:71], v[44:47]
    ds_read_b64_tr_b16 a[192:193], v3 offset:16640
    v_add_f32 v7, v7, v39
    v_mfma_f32_16x16x32_bf16 v[44:47], a[104:107], a[72:75], v[44:47]
    v_exp_f32 v41, v41
    v_mfma_f32_16x16x32_bf16 v[44:47], a[108:111], a[76:79], v[44:47]
    v_add_f32 v7, v7, v40
    v_cvt_pk_bf16_f32 v37, v38, v39
    v_mfma_f32_16x16x32_bf16 v[48:51], a[112:115], a[64:67], v[28:31]
    v_exp_f32 v42, v42
    v_mfma_f32_16x16x32_bf16 v[48:51], a[116:119], a[68:71], v[48:51]
    ds_read_b64_tr_b16 a[194:195], v3 offset:17152
    v_add_f32 v7, v7, v41
    v_mfma_f32_16x16x32_bf16 v[48:51], a[120:123], a[72:75], v[48:51]
    v_exp_f32 v43, v43
    v_mfma_f32_16x16x32_bf16 v[48:51], a[124:127], a[76:79], v[48:51]
    v_add_f32 v7, v7, v42
    v_cvt_pk_bf16_f32 v38, v40, v41
    v_mfma_f32_16x16x32_bf16 v[128:131], a[160:163], v[52:55], v[128:131]
    v_exp_f32 v44, v44
    v_mfma_f32_16x16x32_bf16 v[132:135], a[164:167], v[52:55], v[132:135]
    ds_read_b64_tr_b16 a[196:197], v3 offset:16648
    v_add_f32 v7, v7, v43
    v_mfma_f32_16x16x32_bf16 v[136:139], a[168:171], v[52:55], v[136:139]
    v_exp_f32 v45, v45
    v_mfma_f32_16x16x32_bf16 v[140:143], a[172:175], v[52:55], v[140:143]
    v_add_f32 v8, v8, v44
    v_cvt_pk_bf16_f32 v39, v42, v43
    v_mfma_f32_16x16x32_bf16 v[144:147], a[176:179], v[52:55], v[144:147]
    v_exp_f32 v46, v46
    v_mfma_f32_16x16x32_bf16 v[148:151], a[180:183], v[52:55], v[148:151]
    ds_read_b64_tr_b16 a[198:199], v3 offset:17160
    v_add_f32 v8, v8, v45
    v_mfma_f32_16x16x32_bf16 v[152:155], a[184:187], v[52:55], v[152:155]
    v_exp_f32 v47, v47
    v_mfma_f32_16x16x32_bf16 v[156:159], a[188:191], v[52:55], v[156:159]
    v_add_f32 v8, v8, v46
    v_cvt_pk_bf16_f32 v44, v44, v45
    v_mfma_f32_16x16x32_bf16 v[52:55], a[96:99], a[80:83], v[32:35]
    v_exp_f32 v48, v48
    v_mfma_f32_16x16x32_bf16 v[52:55], a[100:103], a[84:87], v[52:55]
    ds_read_b64_tr_b16 a[200:201], v3 offset:16704
    v_add_f32 v8, v8, v47
    v_mfma_f32_16x16x32_bf16 v[52:55], a[104:107], a[88:91], v[52:55]
    v_exp_f32 v49, v49
    v_mfma_f32_16x16x32_bf16 v[52:55], a[108:111], a[92:95], v[52:55]
    v_add_f32 v8, v8, v48
    v_cvt_pk_bf16_f32 v45, v46, v47
    v_mfma_f32_16x16x32_bf16 v[56:59], a[112:115], a[80:83], v[32:35]
    v_exp_f32 v50, v50
    v_mfma_f32_16x16x32_bf16 v[56:59], a[116:119], a[84:87], v[56:59]
    ds_read_b64_tr_b16 a[202:203], v3 offset:17216
    v_add_f32 v8, v8, v49
    v_mfma_f32_16x16x32_bf16 v[56:59], a[120:123], a[88:91], v[56:59]
    v_exp_f32 v51, v51
    v_mfma_f32_16x16x32_bf16 v[56:59], a[124:127], a[92:95], v[56:59]
    v_add_f32 v8, v8, v50
    v_cvt_pk_bf16_f32 v46, v48, v49
    v_mfma_f32_16x16x32_bf16 v[160:163], a[160:163], v[36:39], v[160:163]
    v_exp_f32 v52, v52
    v_mfma_f32_16x16x32_bf16 v[164:167], a[164:167], v[36:39], v[164:167]
    ds_read_b64_tr_b16 a[204:205], v3 offset:16712
    v_add_f32 v8, v8, v51
    v_mfma_f32_16x16x32_bf16 v[168:171], a[168:171], v[36:39], v[168:171]
    v_exp_f32 v53, v53
    v_mfma_f32_16x16x32_bf16 v[172:175], a[172:175], v[36:39], v[172:175]
    v_add_f32 v9, v9, v52
    v_cvt_pk_bf16_f32 v47, v50, v51
    v_mfma_f32_16x16x32_bf16 v[176:179], a[176:179], v[36:39], v[176:179]
    v_exp_f32 v54, v54
    v_mfma_f32_16x16x32_bf16 v[180:183], a[180:183], v[36:39], v[180:183]
    ds_read_b64_tr_b16 a[206:207], v3 offset:17224
    v_add_f32 v9, v9, v53
    v_mfma_f32_16x16x32_bf16 v[184:187], a[184:187], v[36:39], v[184:187]
    v_exp_f32 v55, v55
    v_mfma_f32_16x16x32_bf16 v[188:191], a[188:191], v[36:39], v[188:191]
    s_waitcnt lgkmcnt(8)
    v_add_f32 v9, v9, v54
    v_cvt_pk_bf16_f32 v52, v52, v53
    v_mfma_f32_16x16x32_bf16 v[36:39], a[128:131], a[0:3], v[12:15]
    v_exp_f32 v56, v56
    v_mfma_f32_16x16x32_bf16 v[36:39], a[132:135], a[4:7], v[36:39]
    ds_read_b64_tr_b16 a[208:209], v3 offset:16768
    v_add_f32 v9, v9, v55
    v_mfma_f32_16x16x32_bf16 v[36:39], a[136:139], a[8:11], v[36:39]
    v_exp_f32 v57, v57
    v_mfma_f32_16x16x32_bf16 v[36:39], a[140:143], a[12:15], v[36:39]
    v_add_f32 v9, v9, v56
    v_cvt_pk_bf16_f32 v53, v54, v55
    v_mfma_f32_16x16x32_bf16 v[40:43], a[144:147], a[0:3], v[12:15]
    s_add_u32 s26, s26, 33280
    v_exp_f32 v58, v58
    v_mfma_f32_16x16x32_bf16 v[40:43], a[148:151], a[4:7], v[40:43]
    s_cmp_eq_u32 s26, 133120
    ds_read_b64_tr_b16 a[210:211], v3 offset:17280
    v_add_f32 v9, v9, v57
    v_mfma_f32_16x16x32_bf16 v[40:43], a[152:155], a[8:11], v[40:43]
    s_cselect_b32 s32, 4294867456, s46
    v_exp_f32 v59, v59
    v_mfma_f32_16x16x32_bf16 v[40:43], a[156:159], a[12:15], v[40:43]
    s_cselect_b32 s26, 0, s26
    v_add_f32 v9, v9, v58
    v_cvt_pk_bf16_f32 v54, v56, v57
    v_mfma_f32_16x16x32_bf16 v[192:195], a[160:163], v[44:47], v[192:195]
    v_exp_f32 v36, v36
    v_mfma_f32_16x16x32_bf16 v[196:199], a[164:167], v[44:47], v[196:199]
    ds_read_b64_tr_b16 a[212:213], v3 offset:16776
    v_add_f32 v9, v9, v59
    v_mfma_f32_16x16x32_bf16 v[200:203], a[168:171], v[44:47], v[200:203]
    v_exp_f32 v37, v37
    v_mfma_f32_16x16x32_bf16 v[204:207], a[172:175], v[44:47], v[204:207]
    v_add_f32 v4, v4, v36
    v_cvt_pk_bf16_f32 v55, v58, v59
    v_mfma_f32_16x16x32_bf16 v[208:211], a[176:179], v[44:47], v[208:211]
    v_exp_f32 v38, v38
    v_mfma_f32_16x16x32_bf16 v[212:215], a[180:183], v[44:47], v[212:215]
    ds_read_b64_tr_b16 a[214:215], v3 offset:17288
    v_add_f32 v4, v4, v37
    v_mfma_f32_16x16x32_bf16 v[216:219], a[184:187], v[44:47], v[216:219]
    v_exp_f32 v39, v39
    v_mfma_f32_16x16x32_bf16 v[220:223], a[188:191], v[44:47], v[220:223]
    v_add_f32 v4, v4, v38
    v_cvt_pk_bf16_f32 v36, v36, v37
    v_mfma_f32_16x16x32_bf16 v[44:47], a[128:131], a[16:19], v[16:19]
    v_exp_f32 v40, v40
    v_mfma_f32_16x16x32_bf16 v[44:47], a[132:135], a[20:23], v[44:47]
    ds_read_b64_tr_b16 a[216:217], v3 offset:16832
    v_add_f32 v4, v4, v39
    v_mfma_f32_16x16x32_bf16 v[44:47], a[136:139], a[24:27], v[44:47]
    v_exp_f32 v41, v41
    v_mfma_f32_16x16x32_bf16 v[44:47], a[140:143], a[28:31], v[44:47]
    v_add_f32 v4, v4, v40
    v_cvt_pk_bf16_f32 v37, v38, v39
    v_mfma_f32_16x16x32_bf16 v[48:51], a[144:147], a[16:19], v[16:19]
    v_exp_f32 v42, v42
    v_mfma_f32_16x16x32_bf16 v[48:51], a[148:151], a[20:23], v[48:51]
    ds_read_b64_tr_b16 a[218:219], v3 offset:17344
    v_add_f32 v4, v4, v41
    v_mfma_f32_16x16x32_bf16 v[48:51], a[152:155], a[24:27], v[48:51]
    v_exp_f32 v43, v43
    v_add_u32 v2, s32, v2
    v_mfma_f32_16x16x32_bf16 v[48:51], a[156:159], a[28:31], v[48:51]
    v_add_f32 v4, v4, v42
    v_cvt_pk_bf16_f32 v38, v40, v41
    v_mfma_f32_16x16x32_bf16 v[224:227], a[160:163], v[52:55], v[224:227]
    v_exp_f32 v44, v44
    v_mfma_f32_16x16x32_bf16 v[228:231], a[164:167], v[52:55], v[228:231]
    ds_read_b64_tr_b16 a[220:221], v3 offset:16840
    v_add_f32 v4, v4, v43
    v_mfma_f32_16x16x32_bf16 v[232:235], a[168:171], v[52:55], v[232:235]
    v_exp_f32 v45, v45
    v_mfma_f32_16x16x32_bf16 v[236:239], a[172:175], v[52:55], v[236:239]
    v_add_f32 v5, v5, v44
    v_cvt_pk_bf16_f32 v39, v42, v43
    v_mfma_f32_16x16x32_bf16 v[240:243], a[176:179], v[52:55], v[240:243]
    v_exp_f32 v46, v46
    v_mfma_f32_16x16x32_bf16 v[244:247], a[180:183], v[52:55], v[244:247]
    ds_read_b64_tr_b16 a[222:223], v3 offset:17352
    v_add_f32 v5, v5, v45
    v_mfma_f32_16x16x32_bf16 v[248:251], a[184:187], v[52:55], v[248:251]
    s_barrier
    v_exp_f32 v47, v47
    v_mfma_f32_16x16x32_bf16 v[252:255], a[188:191], v[52:55], v[252:255]
    v_add_f32 v5, v5, v46
    v_cvt_pk_bf16_f32 v44, v44, v45
    v_mfma_f32_16x16x32_bf16 v[52:55], a[128:131], a[32:35], v[20:23]
    v_exp_f32 v48, v48
    v_mfma_f32_16x16x32_bf16 v[52:55], a[132:135], a[36:39], v[52:55]
    ds_read_b128 a[96:99], v2 offset:0
    v_add_f32 v5, v5, v47
    v_mfma_f32_16x16x32_bf16 v[52:55], a[136:139], a[40:43], v[52:55]
    v_exp_f32 v49, v49
    v_mfma_f32_16x16x32_bf16 v[52:55], a[140:143], a[44:47], v[52:55]
    v_add_f32 v5, v5, v48
    v_cvt_pk_bf16_f32 v45, v46, v47
    v_mfma_f32_16x16x32_bf16 v[56:59], a[144:147], a[32:35], v[20:23]
    v_exp_f32 v50, v50
    v_mfma_f32_16x16x32_bf16 v[56:59], a[148:151], a[36:39], v[56:59]
    ds_read_b128 a[100:103], v2 offset:64
    v_add_f32 v5, v5, v49
    v_mfma_f32_16x16x32_bf16 v[56:59], a[152:155], a[40:43], v[56:59]
    v_exp_f32 v51, v51
    v_mfma_f32_16x16x32_bf16 v[56:59], a[156:159], a[44:47], v[56:59]
    s_waitcnt lgkmcnt(2)
    v_add_f32 v5, v5, v50
    v_cvt_pk_bf16_f32 v46, v48, v49
    v_mfma_f32_16x16x32_bf16 v[64:67], a[192:195], v[36:39], v[64:67]
    v_exp_f32 v52, v52
    v_mfma_f32_16x16x32_bf16 v[68:71], a[196:199], v[36:39], v[68:71]
    ds_read_b128 a[104:107], v2 offset:128
    v_add_f32 v5, v5, v51
    v_mfma_f32_16x16x32_bf16 v[72:75], a[200:203], v[36:39], v[72:75]
    v_exp_f32 v53, v53
    v_mfma_f32_16x16x32_bf16 v[76:79], a[204:207], v[36:39], v[76:79]
    v_add_f32 v6, v6, v52
    v_cvt_pk_bf16_f32 v47, v50, v51
    v_mfma_f32_16x16x32_bf16 v[80:83], a[208:211], v[36:39], v[80:83]
    v_exp_f32 v54, v54
    v_mfma_f32_16x16x32_bf16 v[84:87], a[212:215], v[36:39], v[84:87]
    ds_read_b128 a[108:111], v2 offset:192
    v_add_f32 v6, v6, v53
    v_mfma_f32_16x16x32_bf16 v[88:91], a[216:219], v[36:39], v[88:91]
    v_exp_f32 v55, v55
    v_add_u32 v3, s32, v3
    v_mfma_f32_16x16x32_bf16 v[92:95], a[220:223], v[36:39], v[92:95]
    v_add_f32 v6, v6, v54
    v_cvt_pk_bf16_f32 v52, v52, v53
    v_mfma_f32_16x16x32_bf16 v[36:39], a[128:131], a[48:51], v[24:27]
    s_add_u32 s22, s22, 1
    v_exp_f32 v56, v56
    v_mfma_f32_16x16x32_bf16 v[36:39], a[132:135], a[52:55], v[36:39]
    ds_read_b128 a[112:115], v2 offset:512
    v_add_f32 v6, v6, v55
    v_mfma_f32_16x16x32_bf16 v[36:39], a[136:139], a[56:59], v[36:39]
    v_exp_f32 v57, v57
    v_mfma_f32_16x16x32_bf16 v[36:39], a[140:143], a[60:63], v[36:39]
    v_add_f32 v6, v6, v56
    v_cvt_pk_bf16_f32 v53, v54, v55
    v_mfma_f32_16x16x32_bf16 v[40:43], a[144:147], a[48:51], v[24:27]
    v_exp_f32 v58, v58
    v_mfma_f32_16x16x32_bf16 v[40:43], a[148:151], a[52:55], v[40:43]
    ds_read_b128 a[116:119], v2 offset:576
    v_add_f32 v6, v6, v57
    v_mfma_f32_16x16x32_bf16 v[40:43], a[152:155], a[56:59], v[40:43]
    v_exp_f32 v59, v59
    v_mfma_f32_16x16x32_bf16 v[40:43], a[156:159], a[60:63], v[40:43]
    v_add_f32 v6, v6, v58
    v_cvt_pk_bf16_f32 v54, v56, v57
    v_mfma_f32_16x16x32_bf16 v[96:99], a[192:195], v[44:47], v[96:99]
    v_exp_f32 v36, v36
    v_mfma_f32_16x16x32_bf16 v[100:103], a[196:199], v[44:47], v[100:103]
    ds_read_b128 a[120:123], v2 offset:640
    v_add_f32 v6, v6, v59
    v_mfma_f32_16x16x32_bf16 v[104:107], a[200:203], v[44:47], v[104:107]
    v_exp_f32 v37, v37
    v_mfma_f32_16x16x32_bf16 v[108:111], a[204:207], v[44:47], v[108:111]
    v_add_f32 v7, v7, v36
    v_cvt_pk_bf16_f32 v55, v58, v59
    v_mfma_f32_16x16x32_bf16 v[112:115], a[208:211], v[44:47], v[112:115]
    v_exp_f32 v38, v38
    v_mfma_f32_16x16x32_bf16 v[116:119], a[212:215], v[44:47], v[116:119]
    ds_read_b128 a[124:127], v2 offset:704
    v_add_f32 v7, v7, v37
    v_mfma_f32_16x16x32_bf16 v[120:123], a[216:219], v[44:47], v[120:123]
    v_exp_f32 v39, v39
    v_mfma_f32_16x16x32_bf16 v[124:127], a[220:223], v[44:47], v[124:127]
    v_add_f32 v7, v7, v38
    v_cvt_pk_bf16_f32 v36, v36, v37
    v_mfma_f32_16x16x32_bf16 v[44:47], a[128:131], a[64:67], v[28:31]
    v_exp_f32 v40, v40
    v_mfma_f32_16x16x32_bf16 v[44:47], a[132:135], a[68:71], v[44:47]
    ds_read_b64_tr_b16 a[160:161], v3 offset:0
    v_add_f32 v7, v7, v39
    v_mfma_f32_16x16x32_bf16 v[44:47], a[136:139], a[72:75], v[44:47]
    v_exp_f32 v41, v41
    v_mfma_f32_16x16x32_bf16 v[44:47], a[140:143], a[76:79], v[44:47]
    v_add_f32 v7, v7, v40
    v_cvt_pk_bf16_f32 v37, v38, v39
    v_mfma_f32_16x16x32_bf16 v[48:51], a[144:147], a[64:67], v[28:31]
    v_exp_f32 v42, v42
    v_mfma_f32_16x16x32_bf16 v[48:51], a[148:151], a[68:71], v[48:51]
    ds_read_b64_tr_b16 a[162:163], v3 offset:512
    v_add_f32 v7, v7, v41
    v_mfma_f32_16x16x32_bf16 v[48:51], a[152:155], a[72:75], v[48:51]
    v_exp_f32 v43, v43
    v_mfma_f32_16x16x32_bf16 v[48:51], a[156:159], a[76:79], v[48:51]
    v_add_f32 v7, v7, v42
    v_cvt_pk_bf16_f32 v38, v40, v41
    v_mfma_f32_16x16x32_bf16 v[128:131], a[192:195], v[52:55], v[128:131]
    v_exp_f32 v44, v44
    v_mfma_f32_16x16x32_bf16 v[132:135], a[196:199], v[52:55], v[132:135]
    ds_read_b64_tr_b16 a[164:165], v3 offset:8
    v_add_f32 v7, v7, v43
    v_mfma_f32_16x16x32_bf16 v[136:139], a[200:203], v[52:55], v[136:139]
    v_exp_f32 v45, v45
    v_mfma_f32_16x16x32_bf16 v[140:143], a[204:207], v[52:55], v[140:143]
    v_add_f32 v8, v8, v44
    v_cvt_pk_bf16_f32 v39, v42, v43
    v_mfma_f32_16x16x32_bf16 v[144:147], a[208:211], v[52:55], v[144:147]
    v_exp_f32 v46, v46
    v_mfma_f32_16x16x32_bf16 v[148:151], a[212:215], v[52:55], v[148:151]
    ds_read_b64_tr_b16 a[166:167], v3 offset:520
    v_add_f32 v8, v8, v45
    v_mfma_f32_16x16x32_bf16 v[152:155], a[216:219], v[52:55], v[152:155]
    v_exp_f32 v47, v47
    v_mfma_f32_16x16x32_bf16 v[156:159], a[220:223], v[52:55], v[156:159]
    v_add_f32 v8, v8, v46
    v_cvt_pk_bf16_f32 v44, v44, v45
    v_mfma_f32_16x16x32_bf16 v[52:55], a[128:131], a[80:83], v[32:35]
    v_exp_f32 v48, v48
    v_mfma_f32_16x16x32_bf16 v[52:55], a[132:135], a[84:87], v[52:55]
    ds_read_b64_tr_b16 a[168:169], v3 offset:64
    v_add_f32 v8, v8, v47
    v_mfma_f32_16x16x32_bf16 v[52:55], a[136:139], a[88:91], v[52:55]
    v_exp_f32 v49, v49
    v_mfma_f32_16x16x32_bf16 v[52:55], a[140:143], a[92:95], v[52:55]
    v_add_f32 v8, v8, v48
    v_cvt_pk_bf16_f32 v45, v46, v47
    v_mfma_f32_16x16x32_bf16 v[56:59], a[144:147], a[80:83], v[32:35]
    v_exp_f32 v50, v50
    v_mfma_f32_16x16x32_bf16 v[56:59], a[148:151], a[84:87], v[56:59]
    ds_read_b64_tr_b16 a[170:171], v3 offset:576
    v_add_f32 v8, v8, v49
    v_mfma_f32_16x16x32_bf16 v[56:59], a[152:155], a[88:91], v[56:59]
    v_exp_f32 v51, v51
    v_mfma_f32_16x16x32_bf16 v[56:59], a[156:159], a[92:95], v[56:59]
    v_add_f32 v8, v8, v50
    v_cvt_pk_bf16_f32 v46, v48, v49
    v_mfma_f32_16x16x32_bf16 v[160:163], a[192:195], v[36:39], v[160:163]
    v_exp_f32 v52, v52
    v_mfma_f32_16x16x32_bf16 v[164:167], a[196:199], v[36:39], v[164:167]
    ds_read_b64_tr_b16 a[172:173], v3 offset:72
    v_add_f32 v8, v8, v51
    v_mfma_f32_16x16x32_bf16 v[168:171], a[200:203], v[36:39], v[168:171]
    v_exp_f32 v53, v53
    v_mfma_f32_16x16x32_bf16 v[172:175], a[204:207], v[36:39], v[172:175]
    v_add_f32 v9, v9, v52
    v_cvt_pk_bf16_f32 v47, v50, v51
    v_mfma_f32_16x16x32_bf16 v[176:179], a[208:211], v[36:39], v[176:179]
    v_exp_f32 v54, v54
    v_mfma_f32_16x16x32_bf16 v[180:183], a[212:215], v[36:39], v[180:183]
    ds_read_b64_tr_b16 a[174:175], v3 offset:584
    v_add_f32 v9, v9, v53
    v_mfma_f32_16x16x32_bf16 v[184:187], a[216:219], v[36:39], v[184:187]
    s_cmp_lt_u32 s22, 6
    v_exp_f32 v55, v55
    v_mfma_f32_16x16x32_bf16 v[188:191], a[220:223], v[36:39], v[188:191]
    s_waitcnt lgkmcnt(8)
    v_add_f32 v9, v9, v54
    v_cvt_pk_bf16_f32 v52, v52, v53
    s_cbranch_scc1 L_loop
L_ending:
    v_mfma_f32_16x16x32_bf16 v[36:39], a[96:99], a[0:3], v[12:15]
    v_exp_f32 v56, v56
    v_mfma_f32_16x16x32_bf16 v[36:39], a[100:103], a[4:7], v[36:39]
    ds_read_b64_tr_b16 a[176:177], v3 offset:128
    v_add_f32 v9, v9, v55
    v_mfma_f32_16x16x32_bf16 v[36:39], a[104:107], a[8:11], v[36:39]
    v_exp_f32 v57, v57
    v_mfma_f32_16x16x32_bf16 v[36:39], a[108:111], a[12:15], v[36:39]
    v_add_f32 v9, v9, v56
    v_cvt_pk_bf16_f32 v53, v54, v55
    v_mfma_f32_16x16x32_bf16 v[40:43], a[112:115], a[0:3], v[12:15]
    v_exp_f32 v58, v58
    v_mfma_f32_16x16x32_bf16 v[40:43], a[116:119], a[4:7], v[40:43]
    ds_read_b64_tr_b16 a[178:179], v3 offset:640
    v_add_f32 v9, v9, v57
    v_mfma_f32_16x16x32_bf16 v[40:43], a[120:123], a[8:11], v[40:43]
    v_exp_f32 v59, v59
    v_mfma_f32_16x16x32_bf16 v[40:43], a[124:127], a[12:15], v[40:43]
    v_add_f32 v9, v9, v58
    v_cvt_pk_bf16_f32 v54, v56, v57
    v_mfma_f32_16x16x32_bf16 v[192:195], a[192:195], v[44:47], v[192:195]
    v_exp_f32 v36, v36
    v_mfma_f32_16x16x32_bf16 v[196:199], a[196:199], v[44:47], v[196:199]
    ds_read_b64_tr_b16 a[180:181], v3 offset:136
    v_add_f32 v9, v9, v59
    v_mfma_f32_16x16x32_bf16 v[200:203], a[200:203], v[44:47], v[200:203]
    v_exp_f32 v37, v37
    v_mfma_f32_16x16x32_bf16 v[204:207], a[204:207], v[44:47], v[204:207]
    ds_read_b64_tr_b16 a[182:183], v3 offset:648
    v_cvt_pk_bf16_f32 v55, v58, v59
    v_mfma_f32_16x16x32_bf16 v[208:211], a[208:211], v[44:47], v[208:211]
    v_exp_f32 v38, v38
    v_mfma_f32_16x16x32_bf16 v[212:215], a[212:215], v[44:47], v[212:215]
    v_exp_f32 v39, v39
    v_mfma_f32_16x16x32_bf16 v[216:219], a[216:219], v[44:47], v[216:219]
    v_exp_f32 v40, v40
    v_mfma_f32_16x16x32_bf16 v[220:223], a[220:223], v[44:47], v[220:223]
    v_exp_f32 v41, v41
    v_mfma_f32_16x16x32_bf16 v[44:47], a[96:99], a[16:19], v[16:19]
    ds_read_b64_tr_b16 a[184:185], v3 offset:192
    v_cvt_pk_bf16_f32 v36, v36, v37
    v_mfma_f32_16x16x32_bf16 v[44:47], a[100:103], a[20:23], v[44:47]
    ds_read_b64_tr_b16 a[186:187], v3 offset:704
    v_cvt_pk_bf16_f32 v37, v38, v39
    v_mfma_f32_16x16x32_bf16 v[44:47], a[104:107], a[24:27], v[44:47]
    v_exp_f32 v42, v42
    v_mfma_f32_16x16x32_bf16 v[44:47], a[108:111], a[28:31], v[44:47]
    ds_read_b64_tr_b16 a[188:189], v3 offset:200
    v_cvt_pk_bf16_f32 v38, v40, v41
    v_mfma_f32_16x16x32_bf16 v[48:51], a[112:115], a[16:19], v[16:19]
    v_exp_f32 v43, v43
    v_mfma_f32_16x16x32_bf16 v[48:51], a[116:119], a[20:23], v[48:51]
    ds_read_b64_tr_b16 a[190:191], v3 offset:712
    v_cvt_pk_bf16_f32 v39, v42, v43
    v_mfma_f32_16x16x32_bf16 v[48:51], a[120:123], a[24:27], v[48:51]
    ds_read_b128 a[128:131], v2 offset:16640
    v_mfma_f32_16x16x32_bf16 v[48:51], a[124:127], a[28:31], v[48:51]
    ds_read_b128 a[132:135], v2 offset:16704
    v_mfma_f32_16x16x32_bf16 v[224:227], a[192:195], v[52:55], v[224:227]
    ds_read_b128 a[136:139], v2 offset:16768
    v_mfma_f32_16x16x32_bf16 v[228:231], a[196:199], v[52:55], v[228:231]
    ds_read_b128 a[140:143], v2 offset:16832
    v_mfma_f32_16x16x32_bf16 v[232:235], a[200:203], v[52:55], v[232:235]
    ds_read_b128 a[144:147], v2 offset:17152
    v_mfma_f32_16x16x32_bf16 v[236:239], a[204:207], v[52:55], v[236:239]
    v_exp_f32 v44, v44
    v_mfma_f32_16x16x32_bf16 v[240:243], a[208:211], v[52:55], v[240:243]
    ds_read_b128 a[148:151], v2 offset:17216
    v_add_f32 v5, v5, v44
    v_mfma_f32_16x16x32_bf16 v[244:247], a[212:215], v[52:55], v[244:247]
    v_exp_f32 v45, v45
    v_mfma_f32_16x16x32_bf16 v[248:251], a[216:219], v[52:55], v[248:251]
    ds_read_b128 a[152:155], v2 offset:17280
    v_add_f32 v5, v5, v45
    v_mfma_f32_16x16x32_bf16 v[252:255], a[220:223], v[52:55], v[252:255]
    ds_read_b128 a[156:159], v2 offset:17344
    v_cvt_pk_bf16_f32 v44, v44, v45
    v_mfma_f32_16x16x32_bf16 v[52:55], a[96:99], a[32:35], v[20:23]
    v_exp_f32 v46, v46
    v_mfma_f32_16x16x32_bf16 v[52:55], a[100:103], a[36:39], v[52:55]
    v_exp_f32 v47, v47
    v_mfma_f32_16x16x32_bf16 v[52:55], a[104:107], a[40:43], v[52:55]
    v_exp_f32 v48, v48
    v_mfma_f32_16x16x32_bf16 v[52:55], a[108:111], a[44:47], v[52:55]
    v_exp_f32 v49, v49
    v_mfma_f32_16x16x32_bf16 v[56:59], a[112:115], a[32:35], v[20:23]
    v_add_f32 v5, v5, v46
    v_add_f32 v5, v5, v47
    v_mfma_f32_16x16x32_bf16 v[56:59], a[116:119], a[36:39], v[56:59]
    v_cvt_pk_bf16_f32 v45, v46, v47
    v_add_f32 v5, v5, v48
    v_mfma_f32_16x16x32_bf16 v[56:59], a[120:123], a[40:43], v[56:59]
    v_exp_f32 v50, v50
    v_mfma_f32_16x16x32_bf16 v[56:59], a[124:127], a[44:47], v[56:59]
    v_add_f32 v5, v5, v49
    v_cvt_pk_bf16_f32 v46, v48, v49
    v_mfma_f32_16x16x32_bf16 a[224:227], a[248:251], v[36:39], 0
    s_waitcnt lgkmcnt(0)
    v_exp_f32 v51, v51
    v_mfma_f32_16x16x32_bf16 v[64:67], a[160:163], v[36:39], v[64:67]
    v_add_f32 v5, v5, v50
    v_add_f32 v5, v5, v51
    v_mfma_f32_16x16x32_bf16 v[68:71], a[164:167], v[36:39], v[68:71]
    ds_read_b64_tr_b16 a[192:193], v3 offset:16640
    v_cvt_pk_bf16_f32 v47, v50, v51
    v_mfma_f32_16x16x32_bf16 v[72:75], a[168:171], v[36:39], v[72:75]
    v_exp_f32 v52, v52
    v_mfma_f32_16x16x32_bf16 v[76:79], a[172:175], v[36:39], v[76:79]
    v_exp_f32 v53, v53
    v_mfma_f32_16x16x32_bf16 v[80:83], a[176:179], v[36:39], v[80:83]
    v_exp_f32 v54, v54
    v_mfma_f32_16x16x32_bf16 v[84:87], a[180:183], v[36:39], v[84:87]
    v_exp_f32 v55, v55
    v_mfma_f32_16x16x32_bf16 v[88:91], a[184:187], v[36:39], v[88:91]
    v_exp_f32 v56, v56
    v_mfma_f32_16x16x32_bf16 v[92:95], a[188:191], v[36:39], v[92:95]
    v_exp_f32 v57, v57
    v_mfma_f32_16x16x32_bf16 v[36:39], a[128:131], a[0:3], v[12:15]
    v_cvt_pk_bf16_f32 v52, v52, v53
    v_cvt_pk_bf16_f32 v53, v54, v55
    v_mfma_f32_16x16x32_bf16 v[36:39], a[132:135], a[4:7], v[36:39]
    v_exp_f32 v58, v58
    v_mfma_f32_16x16x32_bf16 v[36:39], a[136:139], a[8:11], v[36:39]
    ds_read_b64_tr_b16 a[194:195], v3 offset:17152
    v_cvt_pk_bf16_f32 v54, v56, v57
    v_mfma_f32_16x16x32_bf16 v[36:39], a[140:143], a[12:15], v[36:39]
    v_exp_f32 v59, v59
    v_mfma_f32_16x16x32_bf16 v[40:43], a[144:147], a[0:3], v[12:15]
    ds_read_b64_tr_b16 a[196:197], v3 offset:16648
    v_cvt_pk_bf16_f32 v55, v58, v59
    v_mfma_f32_16x16x32_bf16 v[40:43], a[148:151], a[4:7], v[40:43]
    ds_read_b64_tr_b16 a[198:199], v3 offset:17160
    v_mfma_f32_16x16x32_bf16 v[40:43], a[152:155], a[8:11], v[40:43]
    ds_read_b64_tr_b16 a[200:201], v3 offset:16704
    v_mfma_f32_16x16x32_bf16 v[40:43], a[156:159], a[12:15], v[40:43]
    v_exp_f32 v36, v36
    v_mfma_f32_16x16x32_bf16 v[96:99], a[160:163], v[44:47], v[96:99]
    ds_read_b64_tr_b16 a[202:203], v3 offset:17216
    v_add_f32 v4, v4, v36
    v_mfma_f32_16x16x32_bf16 v[100:103], a[164:167], v[44:47], v[100:103]
    v_exp_f32 v37, v37
    v_mfma_f32_16x16x32_bf16 v[104:107], a[168:171], v[44:47], v[104:107]
    ds_read_b64_tr_b16 a[204:205], v3 offset:16712
    v_add_f32 v4, v4, v37
    v_mfma_f32_16x16x32_bf16 v[108:111], a[172:175], v[44:47], v[108:111]
    ds_read_b64_tr_b16 a[206:207], v3 offset:17224
    v_cvt_pk_bf16_f32 v36, v36, v37
    v_mfma_f32_16x16x32_bf16 v[112:115], a[176:179], v[44:47], v[112:115]
    v_exp_f32 v38, v38
    v_mfma_f32_16x16x32_bf16 v[116:119], a[180:183], v[44:47], v[116:119]
    ds_read_b64_tr_b16 a[208:209], v3 offset:16768
    v_add_f32 v4, v4, v38
    v_mfma_f32_16x16x32_bf16 v[120:123], a[184:187], v[44:47], v[120:123]
    v_exp_f32 v39, v39
    v_mfma_f32_16x16x32_bf16 v[124:127], a[188:191], v[44:47], v[124:127]
    ds_read_b64_tr_b16 a[210:211], v3 offset:17280
    v_add_f32 v4, v4, v39
    v_mfma_f32_16x16x32_bf16 v[44:47], a[128:131], a[16:19], v[16:19]
    ds_read_b64_tr_b16 a[212:213], v3 offset:16776
    v_cvt_pk_bf16_f32 v37, v38, v39
    v_mfma_f32_16x16x32_bf16 v[44:47], a[132:135], a[20:23], v[44:47]
    v_exp_f32 v40, v40
    v_mfma_f32_16x16x32_bf16 v[44:47], a[136:139], a[24:27], v[44:47]
    ds_read_b64_tr_b16 a[214:215], v3 offset:17288
    v_add_f32 v4, v4, v40
    v_mfma_f32_16x16x32_bf16 v[44:47], a[140:143], a[28:31], v[44:47]
    v_exp_f32 v41, v41
    v_mfma_f32_16x16x32_bf16 v[48:51], a[144:147], a[16:19], v[16:19]
    ds_read_b64_tr_b16 a[216:217], v3 offset:16832
    v_add_f32 v4, v4, v41
    v_mfma_f32_16x16x32_bf16 v[48:51], a[148:151], a[20:23], v[48:51]
    ds_read_b64_tr_b16 a[218:219], v3 offset:17344
    v_cvt_pk_bf16_f32 v38, v40, v41
    v_mfma_f32_16x16x32_bf16 v[48:51], a[152:155], a[24:27], v[48:51]
    v_exp_f32 v42, v42
    v_mfma_f32_16x16x32_bf16 v[48:51], a[156:159], a[28:31], v[48:51]
    ds_read_b64_tr_b16 a[220:221], v3 offset:16840
    v_add_f32 v4, v4, v42
    v_mfma_f32_16x16x32_bf16 a[232:235], a[248:251], v[52:55], 0
    v_exp_f32 v43, v43
    v_mfma_f32_16x16x32_bf16 v[128:131], a[160:163], v[52:55], v[128:131]
    ds_read_b64_tr_b16 a[222:223], v3 offset:17352
    v_add_f32 v4, v4, v43
    v_mfma_f32_16x16x32_bf16 v[132:135], a[164:167], v[52:55], v[132:135]
    v_cvt_pk_bf16_f32 v39, v42, v43
    v_mfma_f32_16x16x32_bf16 v[136:139], a[168:171], v[52:55], v[136:139]
    v_exp_f32 v44, v44
    v_mfma_f32_16x16x32_bf16 v[140:143], a[172:175], v[52:55], v[140:143]
    v_exp_f32 v45, v45
    v_mfma_f32_16x16x32_bf16 v[144:147], a[176:179], v[52:55], v[144:147]
    v_exp_f32 v46, v46
    v_mfma_f32_16x16x32_bf16 v[148:151], a[180:183], v[52:55], v[148:151]
    v_exp_f32 v47, v47
    v_mfma_f32_16x16x32_bf16 v[152:155], a[184:187], v[52:55], v[152:155]
    s_waitcnt vmcnt(0)
    s_barrier
    ds_read_b128 a[96:99], v2 offset:33280
    v_add_f32 v5, v5, v44
    v_mfma_f32_16x16x32_bf16 v[156:159], a[188:191], v[52:55], v[156:159]
    ds_read_b128 a[100:103], v2 offset:33344
    v_add_f32 v5, v5, v45
    v_mfma_f32_16x16x32_bf16 v[52:55], a[128:131], a[32:35], v[20:23]
    ds_read_b128 a[104:107], v2 offset:33408
    v_cvt_pk_bf16_f32 v44, v44, v45
    v_mfma_f32_16x16x32_bf16 v[52:55], a[132:135], a[36:39], v[52:55]
    ds_read_b128 a[108:111], v2 offset:33472
    v_add_f32 v5, v5, v46
    v_mfma_f32_16x16x32_bf16 v[52:55], a[136:139], a[40:43], v[52:55]
    ds_read_b128 a[112:115], v2 offset:33792
    v_add_f32 v5, v5, v47
    v_mfma_f32_16x16x32_bf16 v[52:55], a[140:143], a[44:47], v[52:55]
    ds_read_b128 a[116:119], v2 offset:33856
    v_cvt_pk_bf16_f32 v45, v46, v47
    v_mfma_f32_16x16x32_bf16 v[56:59], a[144:147], a[32:35], v[20:23]
    ds_read_b128 a[120:123], v2 offset:33920
    v_mfma_f32_16x16x32_bf16 v[56:59], a[148:151], a[36:39], v[56:59]
    ds_read_b128 a[124:127], v2 offset:33984
    v_mfma_f32_16x16x32_bf16 v[56:59], a[152:155], a[40:43], v[56:59]
    v_exp_f32 v48, v48
    v_mfma_f32_16x16x32_bf16 v[56:59], a[156:159], a[44:47], v[56:59]
    s_waitcnt lgkmcnt(6)
    v_exp_f32 v49, v49
    v_mfma_f32_16x16x32_bf16 v[64:67], a[192:195], v[36:39], v[64:67]
    v_exp_f32 v50, v50
    v_mfma_f32_16x16x32_bf16 v[68:71], a[196:199], v[36:39], v[68:71]
    v_add_f32 v5, v5, v48
    v_add_f32 v5, v5, v49
    v_mfma_f32_16x16x32_bf16 v[72:75], a[200:203], v[36:39], v[72:75]
    v_cvt_pk_bf16_f32 v46, v48, v49
    v_add_f32 v5, v5, v50
    v_mfma_f32_16x16x32_bf16 v[76:79], a[204:207], v[36:39], v[76:79]
    v_exp_f32 v51, v51
    v_mfma_f32_16x16x32_bf16 v[80:83], a[208:211], v[36:39], v[80:83]
    v_add_f32 v5, v5, v51
    v_cvt_pk_bf16_f32 v47, v50, v51
    v_mfma_f32_16x16x32_bf16 v[84:87], a[212:215], v[36:39], v[84:87]
    ds_read_b128 a[128:131], v2 offset:49920
    v_mfma_f32_16x16x32_bf16 v[88:91], a[216:219], v[36:39], v[88:91]
    ds_read_b128 a[132:135], v2 offset:49984
    v_mfma_f32_16x16x32_bf16 v[92:95], a[220:223], v[36:39], v[92:95]
    ds_read_b128 a[136:139], v2 offset:50048
    v_mfma_f32_16x16x32_bf16 v[36:39], a[96:99], a[0:3], v[12:15]
    ds_read_b128 a[140:143], v2 offset:50112
    v_mfma_f32_16x16x32_bf16 v[36:39], a[100:103], a[4:7], v[36:39]
    s_waitcnt lgkmcnt(4)
    ds_read_b128 a[144:147], v2 offset:50432
    v_mfma_f32_16x16x32_bf16 v[36:39], a[104:107], a[8:11], v[36:39]
    v_exp_f32 v52, v52
    v_mfma_f32_16x16x32_bf16 v[36:39], a[108:111], a[12:15], v[36:39]
    ds_read_b128 a[148:151], v2 offset:50496
    v_mfma_f32_16x16x32_bf16 v[40:43], a[112:115], a[0:3], v[12:15]
    v_exp_f32 v53, v53
    v_mfma_f32_16x16x32_bf16 v[40:43], a[116:119], a[4:7], v[40:43]
    ds_read_b128 a[152:155], v2 offset:50560
    v_cvt_pk_bf16_f32 v52, v52, v53
    v_mfma_f32_16x16x32_bf16 v[40:43], a[120:123], a[8:11], v[40:43]
    ds_read_b128 a[156:159], v2 offset:50624
    v_mfma_f32_16x16x32_bf16 v[40:43], a[124:127], a[12:15], v[40:43]
    v_exp_f32 v54, v54
    v_mfma_f32_16x16x32_bf16 v[96:99], a[192:195], v[44:47], v[96:99]
    v_exp_f32 v55, v55
    v_mfma_f32_16x16x32_bf16 v[100:103], a[196:199], v[44:47], v[100:103]
    v_exp_f32 v56, v56
    v_mfma_f32_16x16x32_bf16 v[104:107], a[200:203], v[44:47], v[104:107]
    v_exp_f32 v57, v57
    v_mfma_f32_16x16x32_bf16 v[108:111], a[204:207], v[44:47], v[108:111]
    v_cvt_pk_bf16_f32 v53, v54, v55
    v_cvt_pk_bf16_f32 v54, v56, v57
    v_mfma_f32_16x16x32_bf16 v[112:115], a[208:211], v[44:47], v[112:115]
    v_exp_f32 v58, v58
    v_mfma_f32_16x16x32_bf16 v[116:119], a[212:215], v[44:47], v[116:119]
    v_exp_f32 v59, v59
    v_mfma_f32_16x16x32_bf16 v[120:123], a[216:219], v[44:47], v[120:123]
    ds_read_b64_tr_b16 a[160:161], v3 offset:33280
    v_cvt_pk_bf16_f32 v55, v58, v59
    v_mfma_f32_16x16x32_bf16 v[124:127], a[220:223], v[44:47], v[124:127]
    s_waitcnt lgkmcnt(1)
    ds_read_b64_tr_b16 a[162:163], v3 offset:33792
    v_mfma_f32_16x16x32_bf16 v[44:47], a[128:131], a[0:3], v[12:15]
    ds_read_b64_tr_b16 a[164:165], v3 offset:33288
    v_mfma_f32_16x16x32_bf16 v[44:47], a[132:135], a[4:7], v[44:47]
    ds_read_b64_tr_b16 a[166:167], v3 offset:33800
    v_mfma_f32_16x16x32_bf16 v[44:47], a[136:139], a[8:11], v[44:47]
    ds_read_b64_tr_b16 a[168:169], v3 offset:33344
    v_mfma_f32_16x16x32_bf16 v[44:47], a[140:143], a[12:15], v[44:47]
    v_exp_f32 v36, v36
    v_mfma_f32_16x16x32_bf16 v[48:51], a[144:147], a[0:3], v[12:15]
    ds_read_b64_tr_b16 a[170:171], v3 offset:33856
    v_add_f32 v4, v4, v36
    v_mfma_f32_16x16x32_bf16 v[48:51], a[148:151], a[4:7], v[48:51]
    v_exp_f32 v37, v37
    v_mfma_f32_16x16x32_bf16 v[48:51], a[152:155], a[8:11], v[48:51]
    ds_read_b64_tr_b16 a[172:173], v3 offset:33352
    v_add_f32 v4, v4, v37
    v_mfma_f32_16x16x32_bf16 v[48:51], a[156:159], a[12:15], v[48:51]
    ds_read_b64_tr_b16 a[174:175], v3 offset:33864
    v_cvt_pk_bf16_f32 v36, v36, v37
    v_mfma_f32_16x16x32_bf16 a[232:235], a[248:251], v[52:55], a[232:235]
    v_exp_f32 v38, v38
    v_mfma_f32_16x16x32_bf16 v[128:131], a[192:195], v[52:55], v[128:131]
    ds_read_b64_tr_b16 a[176:177], v3 offset:33408
    v_add_f32 v4, v4, v38
    v_mfma_f32_16x16x32_bf16 v[132:135], a[196:199], v[52:55], v[132:135]
    v_exp_f32 v39, v39
    v_mfma_f32_16x16x32_bf16 v[136:139], a[200:203], v[52:55], v[136:139]
    ds_read_b64_tr_b16 a[178:179], v3 offset:33920
    v_add_f32 v4, v4, v39
    v_mfma_f32_16x16x32_bf16 v[140:143], a[204:207], v[52:55], v[140:143]
    ds_read_b64_tr_b16 a[180:181], v3 offset:33416
    v_cvt_pk_bf16_f32 v37, v38, v39
    v_mfma_f32_16x16x32_bf16 v[144:147], a[208:211], v[52:55], v[144:147]
    v_exp_f32 v40, v40
    v_mfma_f32_16x16x32_bf16 v[148:151], a[212:215], v[52:55], v[148:151]
    ds_read_b64_tr_b16 a[182:183], v3 offset:33928
    v_add_f32 v4, v4, v40
    v_mfma_f32_16x16x32_bf16 v[152:155], a[216:219], v[52:55], v[152:155]
    v_exp_f32 v41, v41
    v_mfma_f32_16x16x32_bf16 v[156:159], a[220:223], v[52:55], v[156:159]
    ds_read_b64_tr_b16 a[184:185], v3 offset:33472
    v_add_f32 v4, v4, v41
    v_mfma_f32_16x16x32_bf16 v[52:55], a[96:99], a[16:19], v[16:19]
    ds_read_b64_tr_b16 a[186:187], v3 offset:33984
    v_cvt_pk_bf16_f32 v38, v40, v41
    v_mfma_f32_16x16x32_bf16 v[52:55], a[100:103], a[20:23], v[52:55]
    v_exp_f32 v42, v42
    v_mfma_f32_16x16x32_bf16 v[52:55], a[104:107], a[24:27], v[52:55]
    ds_read_b64_tr_b16 a[188:189], v3 offset:33480
    v_add_f32 v4, v4, v42
    v_mfma_f32_16x16x32_bf16 v[52:55], a[108:111], a[28:31], v[52:55]
    v_exp_f32 v43, v43
    v_mfma_f32_16x16x32_bf16 v[56:59], a[112:115], a[16:19], v[16:19]
    ds_read_b64_tr_b16 a[190:191], v3 offset:33992
    v_add_f32 v4, v4, v43
    v_mfma_f32_16x16x32_bf16 v[56:59], a[116:119], a[20:23], v[56:59]
    ds_read_b64_tr_b16 a[192:193], v3 offset:49920
    v_cvt_pk_bf16_f32 v39, v42, v43
    v_mfma_f32_16x16x32_bf16 v[56:59], a[120:123], a[24:27], v[56:59]
    ds_read_b64_tr_b16 a[194:195], v3 offset:50432
    v_mov_b32 v10, v4
    v_mfma_f32_16x16x32_bf16 v[56:59], a[124:127], a[28:31], v[56:59]
    s_waitcnt lgkmcnt(5)
    ds_read_b64_tr_b16 a[196:197], v3 offset:49928
    v_mfma_f32_16x16x32_bf16 v[64:67], a[160:163], v[36:39], v[64:67]
    ds_read_b64_tr_b16 a[198:199], v3 offset:50440
    v_mfma_f32_16x16x32_bf16 v[68:71], a[164:167], v[36:39], v[68:71]
    v_exp_f32 v44, v44
    v_mfma_f32_16x16x32_bf16 v[72:75], a[168:171], v[36:39], v[72:75]
    ds_read_b64_tr_b16 a[200:201], v3 offset:49984
    v_mfma_f32_16x16x32_bf16 v[76:79], a[172:175], v[36:39], v[76:79]
    v_exp_f32 v45, v45
    v_mfma_f32_16x16x32_bf16 v[80:83], a[176:179], v[36:39], v[80:83]
    ds_read_b64_tr_b16 a[202:203], v3 offset:50496
    v_cvt_pk_bf16_f32 v44, v44, v45
    v_mfma_f32_16x16x32_bf16 v[84:87], a[180:183], v[36:39], v[84:87]
    s_waitcnt lgkmcnt(5)
    ds_read_b64_tr_b16 a[204:205], v3 offset:49992
    v_mfma_f32_16x16x32_bf16 v[88:91], a[184:187], v[36:39], v[88:91]
    ds_read_b64_tr_b16 a[206:207], v3 offset:50504
    v_exp_f32 v46, v46
    v_mfma_f32_16x16x32_bf16 v[92:95], a[188:191], v[36:39], v[92:95]
    ds_read_b64_tr_b16 a[208:209], v3 offset:50048
    v_exp_f32 v47, v47
    v_mfma_f32_16x16x32_bf16 v[36:39], a[128:131], a[16:19], v[16:19]
    ds_read_b64_tr_b16 a[210:211], v3 offset:50560
    v_cvt_pk_bf16_f32 v45, v46, v47
    v_mfma_f32_16x16x32_bf16 v[36:39], a[132:135], a[20:23], v[36:39]
    ds_read_b64_tr_b16 a[212:213], v3 offset:50056
    v_exp_f32 v48, v48
    v_mfma_f32_16x16x32_bf16 v[36:39], a[136:139], a[24:27], v[36:39]
    ds_read_b64_tr_b16 a[214:215], v3 offset:50568
    v_exp_f32 v49, v49
    v_mfma_f32_16x16x32_bf16 v[36:39], a[140:143], a[28:31], v[36:39]
    ds_read_b64_tr_b16 a[216:217], v3 offset:50112
    v_cvt_pk_bf16_f32 v46, v48, v49
    v_mfma_f32_16x16x32_bf16 v[40:43], a[144:147], a[16:19], v[16:19]
    ds_read_b64_tr_b16 a[218:219], v3 offset:50624
    v_exp_f32 v50, v50
    v_mfma_f32_16x16x32_bf16 v[40:43], a[148:151], a[20:23], v[40:43]
    ds_read_b64_tr_b16 a[220:221], v3 offset:50120
    v_exp_f32 v51, v51
    v_mfma_f32_16x16x32_bf16 v[40:43], a[152:155], a[24:27], v[40:43]
    ds_read_b64_tr_b16 a[222:223], v3 offset:50632
    v_cvt_pk_bf16_f32 v47, v50, v51
    v_mfma_f32_16x16x32_bf16 v[40:43], a[156:159], a[28:31], v[40:43]
    v_permlane32_swap_b32 v10, v4
    v_mfma_f32_16x16x32_bf16 a[224:227], a[248:251], v[44:47], a[224:227]
    s_waitcnt lgkmcnt(6)
    v_add_f32 v4, v4, v10
    v_mov_b32 v10, v4
    v_mfma_f32_16x16x32_bf16 v[64:67], a[192:195], v[44:47], v[64:67]
    v_exp_f32 v52, v52
    v_mfma_f32_16x16x32_bf16 v[68:71], a[196:199], v[44:47], v[68:71]
    v_permlane16_swap_b32 v10, v4
    v_mfma_f32_16x16x32_bf16 v[72:75], a[200:203], v[44:47], v[72:75]
    v_exp_f32 v53, v53
    v_mfma_f32_16x16x32_bf16 v[76:79], a[204:207], v[44:47], v[76:79]
    v_add_f32 v4, v4, v10
    v_accvgpr_read_b32 v10, a224
    v_mfma_f32_16x16x32_bf16 v[80:83], a[208:211], v[44:47], v[80:83]
    s_waitcnt lgkmcnt(1)
    v_exp_f32 v54, v54
    v_mfma_f32_16x16x32_bf16 v[84:87], a[212:215], v[44:47], v[84:87]
    v_exp_f32 v55, v55
    v_mfma_f32_16x16x32_bf16 v[88:91], a[216:219], v[44:47], v[88:91]
    s_waitcnt lgkmcnt(0)
    v_add_f32 v4, v4, v10
    v_cmp_nge_f32 vcc, s47, v4
    v_mfma_f32_16x16x32_bf16 v[92:95], a[220:223], v[44:47], v[92:95]
    v_exp_f32 v56, v56
    v_mfma_f32_16x16x32_bf16 v[44:47], a[96:99], a[32:35], v[20:23]
    s_or_b64 s[44:45], s[44:45], vcc
    v_exp_f32 v57, v57
    v_mfma_f32_16x16x32_bf16 v[44:47], a[100:103], a[36:39], v[44:47]
    v_rcp_f32 v4, v4
    v_mfma_f32_16x16x32_bf16 v[44:47], a[104:107], a[40:43], v[44:47]
    v_cvt_pk_bf16_f32 v52, v52, v53
    v_cvt_pk_bf16_f32 v53, v54, v55
    v_mfma_f32_16x16x32_bf16 v[44:47], a[108:111], a[44:47], v[44:47]
    v_exp_f32 v58, v58
    v_mfma_f32_16x16x32_bf16 v[48:51], a[112:115], a[32:35], v[20:23]
    v_cvt_pk_bf16_f32 v54, v56, v57
    v_exp_f32 v59, v59
    v_exp_f32 v36, v36
    v_pk_mul_f32 v[64:65], v[64:65], v[4:5] op_sel_hi:[1,0]
    v_pk_mul_f32 v[66:67], v[66:67], v[4:5] op_sel_hi:[1,0]
    v_pk_mul_f32 v[68:69], v[68:69], v[4:5] op_sel_hi:[1,0]
    v_pk_mul_f32 v[70:71], v[70:71], v[4:5] op_sel_hi:[1,0]
    v_pk_mul_f32 v[72:73], v[72:73], v[4:5] op_sel_hi:[1,0]
    v_pk_mul_f32 v[74:75], v[74:75], v[4:5] op_sel_hi:[1,0]
    v_pk_mul_f32 v[76:77], v[76:77], v[4:5] op_sel_hi:[1,0]
    v_pk_mul_f32 v[78:79], v[78:79], v[4:5] op_sel_hi:[1,0]
    v_pk_mul_f32 v[80:81], v[80:81], v[4:5] op_sel_hi:[1,0]
    v_pk_mul_f32 v[82:83], v[82:83], v[4:5] op_sel_hi:[1,0]
    v_pk_mul_f32 v[84:85], v[84:85], v[4:5] op_sel_hi:[1,0]
    v_pk_mul_f32 v[86:87], v[86:87], v[4:5] op_sel_hi:[1,0]
    v_pk_mul_f32 v[88:89], v[88:89], v[4:5] op_sel_hi:[1,0]
    v_pk_mul_f32 v[90:91], v[90:91], v[4:5] op_sel_hi:[1,0]
    v_pk_mul_f32 v[92:93], v[92:93], v[4:5] op_sel_hi:[1,0]
    v_pk_mul_f32 v[94:95], v[94:95], v[4:5] op_sel_hi:[1,0]
    v_mfma_f32_16x16x32_bf16 v[48:51], a[116:119], a[36:39], v[48:51]
    v_cvt_pk_bf16_f32 v64, v64, v65
    v_cvt_pk_bf16_f32 v65, v66, v67
    v_mfma_f32_16x16x32_bf16 v[48:51], a[120:123], a[40:43], v[48:51]
    v_cvt_pk_bf16_f32 v55, v58, v59
    v_cvt_pk_bf16_f32 v66, v68, v69
    v_cvt_pk_bf16_f32 v67, v70, v71
    v_mfma_f32_16x16x32_bf16 v[48:51], a[124:127], a[44:47], v[48:51]
    v_cvt_pk_bf16_f32 v72, v72, v73
    v_cvt_pk_bf16_f32 v73, v74, v75
    v_mfma_f32_16x16x32_bf16 a[228:231], a[248:251], v[52:55], 0
    v_cvt_pk_bf16_f32 v74, v76, v77
    v_cvt_pk_bf16_f32 v75, v78, v79
    v_mfma_f32_16x16x32_bf16 v[96:99], a[160:163], v[52:55], v[96:99]
    buffer_store_dwordx4 v[64:67], v63, s[16:19], 0 offen offset:0 sc1
    buffer_store_dwordx4 v[72:75], v63, s[16:19], 0 offen offset:64 sc1
    v_cvt_pk_bf16_f32 v80, v80, v81
    v_cvt_pk_bf16_f32 v81, v82, v83
    v_mfma_f32_16x16x32_bf16 v[100:103], a[164:167], v[52:55], v[100:103]
    v_cvt_pk_bf16_f32 v82, v84, v85
    v_cvt_pk_bf16_f32 v83, v86, v87
    v_mfma_f32_16x16x32_bf16 v[104:107], a[168:171], v[52:55], v[104:107]
    v_cvt_pk_bf16_f32 v88, v88, v89
    v_cvt_pk_bf16_f32 v89, v90, v91
    v_mfma_f32_16x16x32_bf16 v[108:111], a[172:175], v[52:55], v[108:111]
    v_cvt_pk_bf16_f32 v90, v92, v93
    v_cvt_pk_bf16_f32 v91, v94, v95
    v_mfma_f32_16x16x32_bf16 v[112:115], a[176:179], v[52:55], v[112:115]
    v_exp_f32 v37, v37
    v_mfma_f32_16x16x32_bf16 v[116:119], a[180:183], v[52:55], v[116:119]
    v_exp_f32 v38, v38
    v_mfma_f32_16x16x32_bf16 v[120:123], a[184:187], v[52:55], v[120:123]
    v_exp_f32 v39, v39
    v_mfma_f32_16x16x32_bf16 v[124:127], a[188:191], v[52:55], v[124:127]
    v_exp_f32 v40, v40
    v_mfma_f32_16x16x32_bf16 v[52:55], a[128:131], a[32:35], v[20:23]
    v_exp_f32 v41, v41
    v_mfma_f32_16x16x32_bf16 v[52:55], a[132:135], a[36:39], v[52:55]
    v_cvt_pk_bf16_f32 v36, v36, v37
    v_cvt_pk_bf16_f32 v37, v38, v39
    v_mfma_f32_16x16x32_bf16 v[52:55], a[136:139], a[40:43], v[52:55]
    v_exp_f32 v42, v42
    v_mfma_f32_16x16x32_bf16 v[52:55], a[140:143], a[44:47], v[52:55]
    v_cvt_pk_bf16_f32 v38, v40, v41
    v_mov_b32 v10, v5
    v_mfma_f32_16x16x32_bf16 v[56:59], a[144:147], a[32:35], v[20:23]
    v_exp_f32 v43, v43
    v_mfma_f32_16x16x32_bf16 v[56:59], a[148:151], a[36:39], v[56:59]
    v_cvt_pk_bf16_f32 v39, v42, v43
    v_mfma_f32_16x16x32_bf16 v[56:59], a[152:155], a[40:43], v[56:59]
    v_permlane32_swap_b32 v10, v5
    v_mfma_f32_16x16x32_bf16 v[56:59], a[156:159], a[44:47], v[56:59]
    v_add_f32 v5, v5, v10
    v_mov_b32 v10, v5
    v_mfma_f32_16x16x32_bf16 a[228:231], a[248:251], v[36:39], a[228:231]
    v_exp_f32 v44, v44
    v_mfma_f32_16x16x32_bf16 v[96:99], a[192:195], v[36:39], v[96:99]
    v_permlane16_swap_b32 v10, v5
    v_mfma_f32_16x16x32_bf16 v[100:103], a[196:199], v[36:39], v[100:103]
    v_exp_f32 v45, v45
    v_mfma_f32_16x16x32_bf16 v[104:107], a[200:203], v[36:39], v[104:107]
    v_add_f32 v5, v5, v10
    v_cvt_pk_bf16_f32 v44, v44, v45
    v_mfma_f32_16x16x32_bf16 v[108:111], a[204:207], v[36:39], v[108:111]
    v_exp_f32 v46, v46
    v_mfma_f32_16x16x32_bf16 v[112:115], a[208:211], v[36:39], v[112:115]
    v_exp_f32 v47, v47
    v_mfma_f32_16x16x32_bf16 v[116:119], a[212:215], v[36:39], v[116:119]
    v_accvgpr_read_b32 v10, a228
    v_add_f32 v5, v5, v10
    v_mfma_f32_16x16x32_bf16 v[120:123], a[216:219], v[36:39], v[120:123]
    v_exp_f32 v48, v48
    v_mfma_f32_16x16x32_bf16 v[124:127], a[220:223], v[36:39], v[124:127]
    v_cmp_nge_f32 vcc, s47, v5
    v_cvt_pk_bf16_f32 v45, v46, v47
    v_mfma_f32_16x16x32_bf16 v[36:39], a[96:99], a[48:51], v[24:27]
    v_exp_f32 v49, v49
    v_mfma_f32_16x16x32_bf16 v[36:39], a[100:103], a[52:55], v[36:39]
    s_or_b64 s[44:45], s[44:45], vcc
    v_rcp_f32 v5, v5
    v_mfma_f32_16x16x32_bf16 v[36:39], a[104:107], a[56:59], v[36:39]
    v_exp_f32 v50, v50
    v_mfma_f32_16x16x32_bf16 v[36:39], a[108:111], a[60:63], v[36:39]
    buffer_store_dwordx4 v[80:83], v63, s[16:19], 0 offen offset:128 sc1
    buffer_store_dwordx4 v[88:91], v63, s[16:19], 0 offen offset:192 sc1
    v_mfma_f32_16x16x32_bf16 v[40:43], a[112:115], a[48:51], v[24:27]
    v_cvt_pk_bf16_f32 v46, v48, v49
    v_exp_f32 v51, v51
    v_exp_f32 v52, v52
    v_pk_mul_f32 v[96:97], v[96:97], v[4:5] op_sel:[0,1]
    v_pk_mul_f32 v[98:99], v[98:99], v[4:5] op_sel:[0,1]
    v_pk_mul_f32 v[100:101], v[100:101], v[4:5] op_sel:[0,1]
    v_pk_mul_f32 v[102:103], v[102:103], v[4:5] op_sel:[0,1]
    v_pk_mul_f32 v[104:105], v[104:105], v[4:5] op_sel:[0,1]
    v_pk_mul_f32 v[106:107], v[106:107], v[4:5] op_sel:[0,1]
    v_pk_mul_f32 v[108:109], v[108:109], v[4:5] op_sel:[0,1]
    v_pk_mul_f32 v[110:111], v[110:111], v[4:5] op_sel:[0,1]
    v_pk_mul_f32 v[112:113], v[112:113], v[4:5] op_sel:[0,1]
    v_pk_mul_f32 v[114:115], v[114:115], v[4:5] op_sel:[0,1]
    v_pk_mul_f32 v[116:117], v[116:117], v[4:5] op_sel:[0,1]
    v_pk_mul_f32 v[118:119], v[118:119], v[4:5] op_sel:[0,1]
    v_pk_mul_f32 v[120:121], v[120:121], v[4:5] op_sel:[0,1]
    v_pk_mul_f32 v[122:123], v[122:123], v[4:5] op_sel:[0,1]
    v_pk_mul_f32 v[124:125], v[124:125], v[4:5] op_sel:[0,1]
    v_pk_mul_f32 v[126:127], v[126:127], v[4:5] op_sel:[0,1]
    v_mfma_f32_16x16x32_bf16 v[40:43], a[116:119], a[52:55], v[40:43]
    v_cvt_pk_bf16_f32 v96, v96, v97
    v_cvt_pk_bf16_f32 v97, v98, v99
    v_mfma_f32_16x16x32_bf16 v[40:43], a[120:123], a[56:59], v[40:43]
    v_cvt_pk_bf16_f32 v47, v50, v51
    v_cvt_pk_bf16_f32 v98, v100, v101
    v_cvt_pk_bf16_f32 v99, v102, v103
    v_mfma_f32_16x16x32_bf16 v[40:43], a[124:127], a[60:63], v[40:43]
    v_cvt_pk_bf16_f32 v104, v104, v105
    v_cvt_pk_bf16_f32 v105, v106, v107
    v_mfma_f32_16x16x32_bf16 a[232:235], a[248:251], v[44:47], a[232:235]
    v_cvt_pk_bf16_f32 v106, v108, v109
    v_cvt_pk_bf16_f32 v107, v110, v111
    v_mfma_f32_16x16x32_bf16 v[128:131], a[160:163], v[44:47], v[128:131]
    v_cvt_pk_bf16_f32 v112, v112, v113
    v_cvt_pk_bf16_f32 v113, v114, v115
    v_mfma_f32_16x16x32_bf16 v[132:135], a[164:167], v[44:47], v[132:135]
    v_cvt_pk_bf16_f32 v114, v116, v117
    v_cvt_pk_bf16_f32 v115, v118, v119
    v_mfma_f32_16x16x32_bf16 v[136:139], a[168:171], v[44:47], v[136:139]
    v_cvt_pk_bf16_f32 v120, v120, v121
    v_cvt_pk_bf16_f32 v121, v122, v123
    v_mfma_f32_16x16x32_bf16 v[140:143], a[172:175], v[44:47], v[140:143]
    v_cvt_pk_bf16_f32 v122, v124, v125
    v_cvt_pk_bf16_f32 v123, v126, v127
    v_mfma_f32_16x16x32_bf16 v[144:147], a[176:179], v[44:47], v[144:147]
    v_exp_f32 v53, v53
    v_mfma_f32_16x16x32_bf16 v[148:151], a[180:183], v[44:47], v[148:151]
    v_exp_f32 v54, v54
    v_mfma_f32_16x16x32_bf16 v[152:155], a[184:187], v[44:47], v[152:155]
    v_exp_f32 v55, v55
    v_mfma_f32_16x16x32_bf16 v[156:159], a[188:191], v[44:47], v[156:159]
    v_exp_f32 v56, v56
    v_mfma_f32_16x16x32_bf16 v[44:47], a[96:99], a[64:67], v[28:31]
    v_exp_f32 v57, v57
    v_mfma_f32_16x16x32_bf16 v[44:47], a[100:103], a[68:71], v[44:47]
    v_cvt_pk_bf16_f32 v52, v52, v53
    v_cvt_pk_bf16_f32 v53, v54, v55
    v_mfma_f32_16x16x32_bf16 v[44:47], a[104:107], a[72:75], v[44:47]
    v_exp_f32 v58, v58
    v_mfma_f32_16x16x32_bf16 v[44:47], a[108:111], a[76:79], v[44:47]
    v_cvt_pk_bf16_f32 v54, v56, v57
    v_mov_b32 v10, v6
    v_mfma_f32_16x16x32_bf16 v[48:51], a[112:115], a[64:67], v[28:31]
    v_exp_f32 v59, v59
    v_mfma_f32_16x16x32_bf16 v[48:51], a[116:119], a[68:71], v[48:51]
    ds_read_b128 a[96:99], v2 offset:0
    v_cvt_pk_bf16_f32 v55, v58, v59
    v_mfma_f32_16x16x32_bf16 v[48:51], a[120:123], a[72:75], v[48:51]
    v_permlane32_swap_b32 v10, v6
    v_mfma_f32_16x16x32_bf16 v[48:51], a[124:127], a[76:79], v[48:51]
    v_add_f32 v6, v6, v10
    v_mov_b32 v10, v6
    v_mfma_f32_16x16x32_bf16 a[232:235], a[248:251], v[52:55], a[232:235]
    v_exp_f32 v36, v36
    v_mfma_f32_16x16x32_bf16 v[128:131], a[192:195], v[52:55], v[128:131]
    v_permlane16_swap_b32 v10, v6
    v_mfma_f32_16x16x32_bf16 v[132:135], a[196:199], v[52:55], v[132:135]
    v_exp_f32 v37, v37
    v_mfma_f32_16x16x32_bf16 v[136:139], a[200:203], v[52:55], v[136:139]
    v_add_f32 v6, v6, v10
    v_cvt_pk_bf16_f32 v36, v36, v37
    v_mfma_f32_16x16x32_bf16 v[140:143], a[204:207], v[52:55], v[140:143]
    v_exp_f32 v38, v38
    v_mfma_f32_16x16x32_bf16 v[144:147], a[208:211], v[52:55], v[144:147]
    v_exp_f32 v39, v39
    v_mfma_f32_16x16x32_bf16 v[148:151], a[212:215], v[52:55], v[148:151]
    buffer_store_dwordx4 v[96:99], v63, s[16:19], s97 offen offset:0 sc1
    buffer_store_dwordx4 v[104:107], v63, s[16:19], s97 offen offset:64 sc1
    v_mfma_f32_16x16x32_bf16 v[152:155], a[216:219], v[52:55], v[152:155]
    v_accvgpr_read_b32 v10, a232
    v_add_f32 v6, v6, v10
    v_mfma_f32_16x16x32_bf16 v[156:159], a[220:223], v[52:55], v[156:159]
    v_exp_f32 v40, v40
    v_mfma_f32_16x16x32_bf16 v[52:55], a[128:131], a[48:51], v[24:27]
    v_cmp_nge_f32 vcc, s47, v6
    v_cvt_pk_bf16_f32 v37, v38, v39
    v_mfma_f32_16x16x32_bf16 v[52:55], a[132:135], a[52:55], v[52:55]
    v_exp_f32 v41, v41
    v_mfma_f32_16x16x32_bf16 v[52:55], a[136:139], a[56:59], v[52:55]
    s_or_b64 s[44:45], s[44:45], vcc
    v_rcp_f32 v6, v6
    v_mfma_f32_16x16x32_bf16 v[52:55], a[140:143], a[60:63], v[52:55]
    v_exp_f32 v42, v42
    v_mfma_f32_16x16x32_bf16 v[56:59], a[144:147], a[48:51], v[24:27]
    v_cvt_pk_bf16_f32 v38, v40, v41
    v_exp_f32 v43, v43
    v_exp_f32 v44, v44
    v_pk_mul_f32 v[128:129], v[128:129], v[6:7] op_sel_hi:[1,0]
    v_pk_mul_f32 v[130:131], v[130:131], v[6:7] op_sel_hi:[1,0]
    v_pk_mul_f32 v[132:133], v[132:133], v[6:7] op_sel_hi:[1,0]
    v_pk_mul_f32 v[134:135], v[134:135], v[6:7] op_sel_hi:[1,0]
    v_pk_mul_f32 v[136:137], v[136:137], v[6:7] op_sel_hi:[1,0]
    v_pk_mul_f32 v[138:139], v[138:139], v[6:7] op_sel_hi:[1,0]
    v_pk_mul_f32 v[140:141], v[140:141], v[6:7] op_sel_hi:[1,0]
    v_pk_mul_f32 v[142:143], v[142:143], v[6:7] op_sel_hi:[1,0]
    v_pk_mul_f32 v[144:145], v[144:145], v[6:7] op_sel_hi:[1,0]
    v_pk_mul_f32 v[146:147], v[146:147], v[6:7] op_sel_hi:[1,0]
    v_pk_mul_f32 v[148:149], v[148:149], v[6:7] op_sel_hi:[1,0]
    v_pk_mul_f32 v[150:151], v[150:151], v[6:7] op_sel_hi:[1,0]
    v_pk_mul_f32 v[152:153], v[152:153], v[6:7] op_sel_hi:[1,0]
    v_pk_mul_f32 v[154:155], v[154:155], v[6:7] op_sel_hi:[1,0]
    v_pk_mul_f32 v[156:157], v[156:157], v[6:7] op_sel_hi:[1,0]
    v_pk_mul_f32 v[158:159], v[158:159], v[6:7] op_sel_hi:[1,0]
    v_mfma_f32_16x16x32_bf16 v[56:59], a[148:151], a[52:55], v[56:59]
    v_cvt_pk_bf16_f32 v128, v128, v129
    v_cvt_pk_bf16_f32 v129, v130, v131
    v_mfma_f32_16x16x32_bf16 v[56:59], a[152:155], a[56:59], v[56:59]
    v_cvt_pk_bf16_f32 v39, v42, v43
    v_cvt_pk_bf16_f32 v130, v132, v133
    v_cvt_pk_bf16_f32 v131, v134, v135
    v_mfma_f32_16x16x32_bf16 v[56:59], a[156:159], a[60:63], v[56:59]
    v_cvt_pk_bf16_f32 v136, v136, v137
    v_cvt_pk_bf16_f32 v137, v138, v139
    v_mfma_f32_16x16x32_bf16 a[236:239], a[248:251], v[36:39], 0
    v_cvt_pk_bf16_f32 v138, v140, v141
    v_cvt_pk_bf16_f32 v139, v142, v143
    v_mfma_f32_16x16x32_bf16 v[160:163], a[160:163], v[36:39], v[160:163]
    v_cvt_pk_bf16_f32 v144, v144, v145
    v_cvt_pk_bf16_f32 v145, v146, v147
    v_mfma_f32_16x16x32_bf16 v[164:167], a[164:167], v[36:39], v[164:167]
    v_cvt_pk_bf16_f32 v146, v148, v149
    v_cvt_pk_bf16_f32 v147, v150, v151
    v_mfma_f32_16x16x32_bf16 v[168:171], a[168:171], v[36:39], v[168:171]
    v_cvt_pk_bf16_f32 v152, v152, v153
    v_cvt_pk_bf16_f32 v153, v154, v155
    v_mfma_f32_16x16x32_bf16 v[172:175], a[172:175], v[36:39], v[172:175]
    v_cvt_pk_bf16_f32 v154, v156, v157
    v_cvt_pk_bf16_f32 v155, v158, v159
    v_mfma_f32_16x16x32_bf16 v[176:179], a[176:179], v[36:39], v[176:179]
    v_exp_f32 v45, v45
    v_mfma_f32_16x16x32_bf16 v[180:183], a[180:183], v[36:39], v[180:183]
    v_exp_f32 v46, v46
    v_mfma_f32_16x16x32_bf16 v[184:187], a[184:187], v[36:39], v[184:187]
    v_exp_f32 v47, v47
    v_mfma_f32_16x16x32_bf16 v[188:191], a[188:191], v[36:39], v[188:191]
    v_exp_f32 v48, v48
    v_mfma_f32_16x16x32_bf16 v[36:39], a[128:131], a[64:67], v[28:31]
    v_exp_f32 v49, v49
    v_mfma_f32_16x16x32_bf16 v[36:39], a[132:135], a[68:71], v[36:39]
    v_cvt_pk_bf16_f32 v44, v44, v45
    v_cvt_pk_bf16_f32 v45, v46, v47
    v_mfma_f32_16x16x32_bf16 v[36:39], a[136:139], a[72:75], v[36:39]
    v_exp_f32 v50, v50
    v_mfma_f32_16x16x32_bf16 v[36:39], a[140:143], a[76:79], v[36:39]
    ds_read_b128 a[100:103], v2 offset:64
    v_cvt_pk_bf16_f32 v46, v48, v49
    v_mfma_f32_16x16x32_bf16 v[40:43], a[144:147], a[64:67], v[28:31]
    v_exp_f32 v51, v51
    v_mfma_f32_16x16x32_bf16 v[40:43], a[148:151], a[68:71], v[40:43]
    ds_read_b128 a[104:107], v2 offset:128
    v_cvt_pk_bf16_f32 v47, v50, v51
    v_mfma_f32_16x16x32_bf16 v[40:43], a[152:155], a[72:75], v[40:43]
    ds_read_b128 a[108:111], v2 offset:192
    v_mov_b32 v10, v7
    v_mfma_f32_16x16x32_bf16 v[40:43], a[156:159], a[76:79], v[40:43]
    ds_read_b128 a[112:115], v2 offset:512
    v_mfma_f32_16x16x32_bf16 a[240:243], a[248:251], v[44:47], 0
    buffer_store_dwordx4 v[112:115], v63, s[16:19], s97 offen offset:128 sc1
    buffer_store_dwordx4 v[120:123], v63, s[16:19], s97 offen offset:192 sc1
    v_mfma_f32_16x16x32_bf16 v[192:195], a[160:163], v[44:47], v[192:195]
    v_exp_f32 v52, v52
    v_mfma_f32_16x16x32_bf16 v[196:199], a[164:167], v[44:47], v[196:199]
    ds_read_b128 a[116:119], v2 offset:576
    v_mfma_f32_16x16x32_bf16 v[200:203], a[168:171], v[44:47], v[200:203]
    v_exp_f32 v53, v53
    v_mfma_f32_16x16x32_bf16 v[204:207], a[172:175], v[44:47], v[204:207]
    ds_read_b128 a[120:123], v2 offset:640
    v_cvt_pk_bf16_f32 v52, v52, v53
    v_mfma_f32_16x16x32_bf16 v[208:211], a[176:179], v[44:47], v[208:211]
    ds_read_b128 a[124:127], v2 offset:704
    v_mfma_f32_16x16x32_bf16 v[212:215], a[180:183], v[44:47], v[212:215]
    v_exp_f32 v54, v54
    v_mfma_f32_16x16x32_bf16 v[216:219], a[184:187], v[44:47], v[216:219]
    v_exp_f32 v55, v55
    v_mfma_f32_16x16x32_bf16 v[220:223], a[188:191], v[44:47], v[220:223]
    s_waitcnt lgkmcnt(3)
    v_exp_f32 v56, v56
    v_mfma_f32_16x16x32_bf16 v[44:47], a[96:99], a[48:51], v[24:27]
    v_exp_f32 v57, v57
    v_mfma_f32_16x16x32_bf16 v[44:47], a[100:103], a[52:55], v[44:47]
    v_cvt_pk_bf16_f32 v53, v54, v55
    v_cvt_pk_bf16_f32 v54, v56, v57
    v_mfma_f32_16x16x32_bf16 v[44:47], a[104:107], a[56:59], v[44:47]
    v_exp_f32 v58, v58
    v_mfma_f32_16x16x32_bf16 v[44:47], a[108:111], a[60:63], v[44:47]
    v_exp_f32 v59, v59
    v_mfma_f32_16x16x32_bf16 v[48:51], a[112:115], a[48:51], v[24:27]
    s_waitcnt lgkmcnt(0)
    ds_read_b128 a[128:131], v2 offset:16640
    v_cvt_pk_bf16_f32 v55, v58, v59
    v_mfma_f32_16x16x32_bf16 v[48:51], a[116:119], a[52:55], v[48:51]
    ds_read_b128 a[132:135], v2 offset:16704
    v_mfma_f32_16x16x32_bf16 v[48:51], a[120:123], a[56:59], v[48:51]
    ds_read_b128 a[136:139], v2 offset:16768
    v_mfma_f32_16x16x32_bf16 v[48:51], a[124:127], a[60:63], v[48:51]
    ds_read_b128 a[140:143], v2 offset:16832
    v_mfma_f32_16x16x32_bf16 a[236:239], a[248:251], v[52:55], a[236:239]
    ds_read_b128 a[144:147], v2 offset:17152
    v_mfma_f32_16x16x32_bf16 v[160:163], a[192:195], v[52:55], v[160:163]
    v_exp_f32 v36, v36
    v_mfma_f32_16x16x32_bf16 v[164:167], a[196:199], v[52:55], v[164:167]
    ds_read_b128 a[148:151], v2 offset:17216
    v_mfma_f32_16x16x32_bf16 v[168:171], a[200:203], v[52:55], v[168:171]
    v_exp_f32 v37, v37
    v_mfma_f32_16x16x32_bf16 v[172:175], a[204:207], v[52:55], v[172:175]
    ds_read_b128 a[152:155], v2 offset:17280
    v_cvt_pk_bf16_f32 v36, v36, v37
    v_mfma_f32_16x16x32_bf16 v[176:179], a[208:211], v[52:55], v[176:179]
    ds_read_b128 a[156:159], v2 offset:17344
    v_mfma_f32_16x16x32_bf16 v[180:183], a[212:215], v[52:55], v[180:183]
    v_exp_f32 v38, v38
    v_mfma_f32_16x16x32_bf16 v[184:187], a[216:219], v[52:55], v[184:187]
    v_exp_f32 v39, v39
    v_mfma_f32_16x16x32_bf16 v[188:191], a[220:223], v[52:55], v[188:191]
    s_waitcnt lgkmcnt(3)
    v_exp_f32 v40, v40
    v_mfma_f32_16x16x32_bf16 v[52:55], a[128:131], a[48:51], v[24:27]
    v_exp_f32 v41, v41
    v_mfma_f32_16x16x32_bf16 v[52:55], a[132:135], a[52:55], v[52:55]
    v_cvt_pk_bf16_f32 v37, v38, v39
    v_cvt_pk_bf16_f32 v38, v40, v41
    v_mfma_f32_16x16x32_bf16 v[52:55], a[136:139], a[56:59], v[52:55]
    buffer_store_dwordx4 v[128:131], v63, s[16:19], s98 offen offset:0 sc1
    buffer_store_dwordx4 v[136:139], v63, s[16:19], s98 offen offset:64 sc1
    v_mfma_f32_16x16x32_bf16 v[52:55], a[140:143], a[60:63], v[52:55]
    v_exp_f32 v42, v42
    v_mfma_f32_16x16x32_bf16 v[56:59], a[144:147], a[48:51], v[24:27]
    s_waitcnt lgkmcnt(0)
    v_exp_f32 v43, v43
    v_mfma_f32_16x16x32_bf16 v[56:59], a[148:151], a[52:55], v[56:59]
    ds_read_b64_tr_b16 a[160:161], v3 offset:0
    v_cvt_pk_bf16_f32 v39, v42, v43
    v_mfma_f32_16x16x32_bf16 v[56:59], a[152:155], a[56:59], v[56:59]
    ds_read_b64_tr_b16 a[162:163], v3 offset:512
    v_mfma_f32_16x16x32_bf16 v[56:59], a[156:159], a[60:63], v[56:59]
    ds_read_b64_tr_b16 a[164:165], v3 offset:8
    v_mfma_f32_16x16x32_bf16 a[240:243], a[248:251], v[36:39], a[240:243]
    ds_read_b64_tr_b16 a[166:167], v3 offset:520
    v_mfma_f32_16x16x32_bf16 v[192:195], a[192:195], v[36:39], v[192:195]
    v_exp_f32 v44, v44
    v_mfma_f32_16x16x32_bf16 v[196:199], a[196:199], v[36:39], v[196:199]
    ds_read_b64_tr_b16 a[168:169], v3 offset:64
    v_mfma_f32_16x16x32_bf16 v[200:203], a[200:203], v[36:39], v[200:203]
    v_exp_f32 v45, v45
    v_mfma_f32_16x16x32_bf16 v[204:207], a[204:207], v[36:39], v[204:207]
    ds_read_b64_tr_b16 a[170:171], v3 offset:576
    v_cvt_pk_bf16_f32 v44, v44, v45
    v_mfma_f32_16x16x32_bf16 v[208:211], a[208:211], v[36:39], v[208:211]
    ds_read_b64_tr_b16 a[172:173], v3 offset:72
    v_mfma_f32_16x16x32_bf16 v[212:215], a[212:215], v[36:39], v[212:215]
    v_exp_f32 v46, v46
    v_mfma_f32_16x16x32_bf16 v[216:219], a[216:219], v[36:39], v[216:219]
    ds_read_b64_tr_b16 a[174:175], v3 offset:584
    v_mfma_f32_16x16x32_bf16 v[220:223], a[220:223], v[36:39], v[220:223]
    ds_read_b64_tr_b16 a[176:177], v3 offset:128
    v_exp_f32 v47, v47
    v_mfma_f32_16x16x32_bf16 v[36:39], a[96:99], a[64:67], v[28:31]
    ds_read_b64_tr_b16 a[178:179], v3 offset:640
    v_cvt_pk_bf16_f32 v45, v46, v47
    v_mfma_f32_16x16x32_bf16 v[36:39], a[100:103], a[68:71], v[36:39]
    ds_read_b64_tr_b16 a[180:181], v3 offset:136
    v_exp_f32 v48, v48
    v_mfma_f32_16x16x32_bf16 v[36:39], a[104:107], a[72:75], v[36:39]
    ds_read_b64_tr_b16 a[182:183], v3 offset:648
    v_exp_f32 v49, v49
    v_mfma_f32_16x16x32_bf16 v[36:39], a[108:111], a[76:79], v[36:39]
    ds_read_b64_tr_b16 a[184:185], v3 offset:192
    v_cvt_pk_bf16_f32 v46, v48, v49
    v_mfma_f32_16x16x32_bf16 v[40:43], a[112:115], a[64:67], v[28:31]
    ds_read_b64_tr_b16 a[186:187], v3 offset:704
    v_exp_f32 v50, v50
    v_mfma_f32_16x16x32_bf16 v[40:43], a[116:119], a[68:71], v[40:43]
    ds_read_b64_tr_b16 a[188:189], v3 offset:200
    v_exp_f32 v51, v51
    v_mfma_f32_16x16x32_bf16 v[40:43], a[120:123], a[72:75], v[40:43]
    ds_read_b64_tr_b16 a[190:191], v3 offset:712
    v_cvt_pk_bf16_f32 v47, v50, v51
    v_mfma_f32_16x16x32_bf16 v[40:43], a[124:127], a[76:79], v[40:43]
    ds_read_b64_tr_b16 a[192:193], v3 offset:16640
    v_mfma_f32_16x16x32_bf16 a[236:239], a[248:251], v[44:47], a[236:239]
    s_waitcnt lgkmcnt(7)
    ds_read_b64_tr_b16 a[194:195], v3 offset:17152
    v_mfma_f32_16x16x32_bf16 v[160:163], a[160:163], v[44:47], v[160:163]
    ds_read_b64_tr_b16 a[196:197], v3 offset:16648
    v_mfma_f32_16x16x32_bf16 v[164:167], a[164:167], v[44:47], v[164:167]
    ds_read_b64_tr_b16 a[198:199], v3 offset:17160
    v_mfma_f32_16x16x32_bf16 v[168:171], a[168:171], v[44:47], v[168:171]
    v_exp_f32 v52, v52
    v_mfma_f32_16x16x32_bf16 v[172:175], a[172:175], v[44:47], v[172:175]
    ds_read_b64_tr_b16 a[200:201], v3 offset:16704
    v_mfma_f32_16x16x32_bf16 v[176:179], a[176:179], v[44:47], v[176:179]
    s_waitcnt lgkmcnt(6)
    buffer_store_dwordx4 v[144:147], v63, s[16:19], s98 offen offset:128 sc1
    buffer_store_dwordx4 v[152:155], v63, s[16:19], s98 offen offset:192 sc1
    ds_read_b64_tr_b16 a[202:203], v3 offset:17216
    v_exp_f32 v53, v53
    v_mfma_f32_16x16x32_bf16 v[180:183], a[180:183], v[44:47], v[180:183]
    ds_read_b64_tr_b16 a[204:205], v3 offset:16712
    v_cvt_pk_bf16_f32 v52, v52, v53
    v_mfma_f32_16x16x32_bf16 v[184:187], a[184:187], v[44:47], v[184:187]
    s_waitcnt lgkmcnt(6)
    ds_read_b64_tr_b16 a[206:207], v3 offset:17224
    v_exp_f32 v54, v54
    v_mfma_f32_16x16x32_bf16 v[188:191], a[188:191], v[44:47], v[188:191]
    ds_read_b64_tr_b16 a[208:209], v3 offset:16768
    v_exp_f32 v55, v55
    v_mfma_f32_16x16x32_bf16 v[44:47], a[128:131], a[64:67], v[28:31]
    ds_read_b64_tr_b16 a[210:211], v3 offset:17280
    v_cvt_pk_bf16_f32 v53, v54, v55
    v_mfma_f32_16x16x32_bf16 v[44:47], a[132:135], a[68:71], v[44:47]
    ds_read_b64_tr_b16 a[212:213], v3 offset:16776
    v_exp_f32 v56, v56
    v_mfma_f32_16x16x32_bf16 v[44:47], a[136:139], a[72:75], v[44:47]
    ds_read_b64_tr_b16 a[214:215], v3 offset:17288
    v_exp_f32 v57, v57
    v_mfma_f32_16x16x32_bf16 v[44:47], a[140:143], a[76:79], v[44:47]
    ds_read_b64_tr_b16 a[216:217], v3 offset:16832
    v_cvt_pk_bf16_f32 v54, v56, v57
    v_mfma_f32_16x16x32_bf16 v[48:51], a[144:147], a[64:67], v[28:31]
    ds_read_b64_tr_b16 a[218:219], v3 offset:17344
    v_exp_f32 v58, v58
    v_mfma_f32_16x16x32_bf16 v[48:51], a[148:151], a[68:71], v[48:51]
    ds_read_b64_tr_b16 a[220:221], v3 offset:16840
    v_exp_f32 v59, v59
    v_mfma_f32_16x16x32_bf16 v[48:51], a[152:155], a[72:75], v[48:51]
    ds_read_b64_tr_b16 a[222:223], v3 offset:17352
    v_cvt_pk_bf16_f32 v55, v58, v59
    v_mfma_f32_16x16x32_bf16 v[48:51], a[156:159], a[76:79], v[48:51]
    v_permlane32_swap_b32 v10, v7
    v_mfma_f32_16x16x32_bf16 a[236:239], a[248:251], v[52:55], a[236:239]
    s_waitcnt lgkmcnt(6)
    v_add_f32 v7, v7, v10
    v_mov_b32 v10, v7
    v_mfma_f32_16x16x32_bf16 v[160:163], a[192:195], v[52:55], v[160:163]
    v_exp_f32 v36, v36
    v_mfma_f32_16x16x32_bf16 v[164:167], a[196:199], v[52:55], v[164:167]
    v_permlane16_swap_b32 v10, v7
    v_mfma_f32_16x16x32_bf16 v[168:171], a[200:203], v[52:55], v[168:171]
    v_exp_f32 v37, v37
    v_mfma_f32_16x16x32_bf16 v[172:175], a[204:207], v[52:55], v[172:175]
    v_add_f32 v7, v7, v10
    v_accvgpr_read_b32 v10, a236
    v_mfma_f32_16x16x32_bf16 v[176:179], a[208:211], v[52:55], v[176:179]
    s_waitcnt lgkmcnt(1)
    v_exp_f32 v38, v38
    v_mfma_f32_16x16x32_bf16 v[180:183], a[212:215], v[52:55], v[180:183]
    v_exp_f32 v39, v39
    v_mfma_f32_16x16x32_bf16 v[184:187], a[216:219], v[52:55], v[184:187]
    s_waitcnt lgkmcnt(0)
    v_add_f32 v7, v7, v10
    v_cmp_nge_f32 vcc, s47, v7
    v_mfma_f32_16x16x32_bf16 v[188:191], a[220:223], v[52:55], v[188:191]
    v_exp_f32 v40, v40
    v_mfma_f32_16x16x32_bf16 v[52:55], a[96:99], a[80:83], v[32:35]
    s_or_b64 s[44:45], s[44:45], vcc
    v_exp_f32 v41, v41
    v_mfma_f32_16x16x32_bf16 v[52:55], a[100:103], a[84:87], v[52:55]
    v_rcp_f32 v7, v7
    v_mfma_f32_16x16x32_bf16 v[52:55], a[104:107], a[88:91], v[52:55]
    v_cvt_pk_bf16_f32 v36, v36, v37
    v_cvt_pk_bf16_f32 v37, v38, v39
    v_mfma_f32_16x16x32_bf16 v[52:55], a[108:111], a[92:95], v[52:55]
    v_exp_f32 v42, v42
    v_mfma_f32_16x16x32_bf16 v[56:59], a[112:115], a[80:83], v[32:35]
    v_cvt_pk_bf16_f32 v38, v40, v41
    v_exp_f32 v43, v43
    v_exp_f32 v44, v44
    v_pk_mul_f32 v[160:161], v[160:161], v[6:7] op_sel:[0,1]
    v_pk_mul_f32 v[162:163], v[162:163], v[6:7] op_sel:[0,1]
    v_pk_mul_f32 v[164:165], v[164:165], v[6:7] op_sel:[0,1]
    v_pk_mul_f32 v[166:167], v[166:167], v[6:7] op_sel:[0,1]
    v_pk_mul_f32 v[168:169], v[168:169], v[6:7] op_sel:[0,1]
    v_pk_mul_f32 v[170:171], v[170:171], v[6:7] op_sel:[0,1]
    v_pk_mul_f32 v[172:173], v[172:173], v[6:7] op_sel:[0,1]
    v_pk_mul_f32 v[174:175], v[174:175], v[6:7] op_sel:[0,1]
    v_pk_mul_f32 v[176:177], v[176:177], v[6:7] op_sel:[0,1]
    v_pk_mul_f32 v[178:179], v[178:179], v[6:7] op_sel:[0,1]
    v_pk_mul_f32 v[180:181], v[180:181], v[6:7] op_sel:[0,1]
    v_pk_mul_f32 v[182:183], v[182:183], v[6:7] op_sel:[0,1]
    v_pk_mul_f32 v[184:185], v[184:185], v[6:7] op_sel:[0,1]
    v_pk_mul_f32 v[186:187], v[186:187], v[6:7] op_sel:[0,1]
    v_pk_mul_f32 v[188:189], v[188:189], v[6:7] op_sel:[0,1]
    v_pk_mul_f32 v[190:191], v[190:191], v[6:7] op_sel:[0,1]
    v_mfma_f32_16x16x32_bf16 v[56:59], a[116:119], a[84:87], v[56:59]
    v_cvt_pk_bf16_f32 v160, v160, v161
    v_cvt_pk_bf16_f32 v161, v162, v163
    v_mfma_f32_16x16x32_bf16 v[56:59], a[120:123], a[88:91], v[56:59]
    v_cvt_pk_bf16_f32 v39, v42, v43
    v_cvt_pk_bf16_f32 v162, v164, v165
    v_cvt_pk_bf16_f32 v163, v166, v167
    v_mfma_f32_16x16x32_bf16 v[56:59], a[124:127], a[92:95], v[56:59]
    v_cvt_pk_bf16_f32 v168, v168, v169
    v_cvt_pk_bf16_f32 v169, v170, v171
    v_mfma_f32_16x16x32_bf16 a[240:243], a[248:251], v[36:39], a[240:243]
    v_cvt_pk_bf16_f32 v170, v172, v173
    v_cvt_pk_bf16_f32 v171, v174, v175
    v_mfma_f32_16x16x32_bf16 v[192:195], a[160:163], v[36:39], v[192:195]
    buffer_store_dwordx4 v[160:163], v63, s[16:19], s99 offen offset:0 sc1
    buffer_store_dwordx4 v[168:171], v63, s[16:19], s99 offen offset:64 sc1
    v_cvt_pk_bf16_f32 v176, v176, v177
    v_cvt_pk_bf16_f32 v177, v178, v179
    v_mfma_f32_16x16x32_bf16 v[196:199], a[164:167], v[36:39], v[196:199]
    v_cvt_pk_bf16_f32 v178, v180, v181
    v_cvt_pk_bf16_f32 v179, v182, v183
    v_mfma_f32_16x16x32_bf16 v[200:203], a[168:171], v[36:39], v[200:203]
    v_cvt_pk_bf16_f32 v184, v184, v185
    v_cvt_pk_bf16_f32 v185, v186, v187
    v_mfma_f32_16x16x32_bf16 v[204:207], a[172:175], v[36:39], v[204:207]
    v_cvt_pk_bf16_f32 v186, v188, v189
    v_cvt_pk_bf16_f32 v187, v190, v191
    v_mfma_f32_16x16x32_bf16 v[208:211], a[176:179], v[36:39], v[208:211]
    v_exp_f32 v45, v45
    v_mfma_f32_16x16x32_bf16 v[212:215], a[180:183], v[36:39], v[212:215]
    v_exp_f32 v46, v46
    v_mfma_f32_16x16x32_bf16 v[216:219], a[184:187], v[36:39], v[216:219]
    v_exp_f32 v47, v47
    v_mfma_f32_16x16x32_bf16 v[220:223], a[188:191], v[36:39], v[220:223]
    v_exp_f32 v48, v48
    v_mfma_f32_16x16x32_bf16 v[36:39], a[128:131], a[80:83], v[32:35]
    v_exp_f32 v49, v49
    v_mfma_f32_16x16x32_bf16 v[36:39], a[132:135], a[84:87], v[36:39]
    v_cvt_pk_bf16_f32 v44, v44, v45
    v_cvt_pk_bf16_f32 v45, v46, v47
    v_mfma_f32_16x16x32_bf16 v[36:39], a[136:139], a[88:91], v[36:39]
    v_exp_f32 v50, v50
    v_mfma_f32_16x16x32_bf16 v[36:39], a[140:143], a[92:95], v[36:39]
    ds_read_b128 a[96:99], v2 offset:33280
    v_cvt_pk_bf16_f32 v46, v48, v49
    v_mfma_f32_16x16x32_bf16 v[40:43], a[144:147], a[80:83], v[32:35]
    v_exp_f32 v51, v51
    v_mfma_f32_16x16x32_bf16 v[40:43], a[148:151], a[84:87], v[40:43]
    ds_read_b128 a[100:103], v2 offset:33344
    v_cvt_pk_bf16_f32 v47, v50, v51
    v_mfma_f32_16x16x32_bf16 v[40:43], a[152:155], a[88:91], v[40:43]
    ds_read_b128 a[104:107], v2 offset:33408
    v_mov_b32 v10, v8
    v_mfma_f32_16x16x32_bf16 v[40:43], a[156:159], a[92:95], v[40:43]
    s_nop 0
    v_permlane32_swap_b32 v10, v8
    v_mfma_f32_16x16x32_bf16 a[240:243], a[248:251], v[44:47], a[240:243]
    ds_read_b128 a[108:111], v2 offset:33472
    v_add_f32 v8, v8, v10
    v_mfma_f32_16x16x32_bf16 v[192:195], a[192:195], v[44:47], v[192:195]
    ds_read_b128 a[112:115], v2 offset:33792
    v_mov_b32 v10, v8
    v_mfma_f32_16x16x32_bf16 v[196:199], a[196:199], v[44:47], v[196:199]
    v_exp_f32 v52, v52
    v_mfma_f32_16x16x32_bf16 v[200:203], a[200:203], v[44:47], v[200:203]
    ds_read_b128 a[116:119], v2 offset:33856
    v_mfma_f32_16x16x32_bf16 v[204:207], a[204:207], v[44:47], v[204:207]
    v_permlane16_swap_b32 v10, v8
    v_mfma_f32_16x16x32_bf16 v[208:211], a[208:211], v[44:47], v[208:211]
    ds_read_b128 a[120:123], v2 offset:33920
    v_exp_f32 v53, v53
    v_add_f32 v8, v8, v10
    v_mfma_f32_16x16x32_bf16 v[212:215], a[212:215], v[44:47], v[212:215]
    ds_read_b128 a[124:127], v2 offset:33984
    v_accvgpr_read_b32 v10, a240
    v_mfma_f32_16x16x32_bf16 v[216:219], a[216:219], v[44:47], v[216:219]
    v_exp_f32 v54, v54
    v_mfma_f32_16x16x32_bf16 v[220:223], a[220:223], v[44:47], v[220:223]
    s_waitcnt lgkmcnt(4)
    v_exp_f32 v55, v55
    v_mfma_f32_16x16x32_bf16 v[44:47], a[96:99], a[80:83], v[32:35]
    v_add_f32 v8, v8, v10
    v_cmp_nge_f32 vcc, s47, v8
    v_mfma_f32_16x16x32_bf16 v[44:47], a[100:103], a[84:87], v[44:47]
    v_exp_f32 v56, v56
    v_mfma_f32_16x16x32_bf16 v[44:47], a[104:107], a[88:91], v[44:47]
    v_exp_f32 v57, v57
    v_rcp_f32 v8, v8
    v_mfma_f32_16x16x32_bf16 v[44:47], a[108:111], a[92:95], v[44:47]
    s_waitcnt lgkmcnt(2)
    buffer_store_dwordx4 v[176:179], v63, s[16:19], s99 offen offset:128 sc1
    buffer_store_dwordx4 v[184:187], v63, s[16:19], s99 offen offset:192 sc1
    v_cvt_pk_bf16_f32 v52, v52, v53
    v_mfma_f32_16x16x32_bf16 v[48:51], a[112:115], a[80:83], v[32:35]
    s_or_b64 s[44:45], s[44:45], vcc
    ds_read_b128 a[128:131], v2 offset:49920
    v_cvt_pk_bf16_f32 v53, v54, v55
    v_exp_f32 v58, v58
    v_cvt_pk_bf16_f32 v54, v56, v57
    v_pk_mul_f32 v[192:193], v[192:193], v[8:9] op_sel_hi:[1,0]
    v_pk_mul_f32 v[194:195], v[194:195], v[8:9] op_sel_hi:[1,0]
    v_pk_mul_f32 v[196:197], v[196:197], v[8:9] op_sel_hi:[1,0]
    v_pk_mul_f32 v[198:199], v[198:199], v[8:9] op_sel_hi:[1,0]
    v_pk_mul_f32 v[200:201], v[200:201], v[8:9] op_sel_hi:[1,0]
    v_pk_mul_f32 v[202:203], v[202:203], v[8:9] op_sel_hi:[1,0]
    v_pk_mul_f32 v[204:205], v[204:205], v[8:9] op_sel_hi:[1,0]
    v_pk_mul_f32 v[206:207], v[206:207], v[8:9] op_sel_hi:[1,0]
    v_pk_mul_f32 v[208:209], v[208:209], v[8:9] op_sel_hi:[1,0]
    v_pk_mul_f32 v[210:211], v[210:211], v[8:9] op_sel_hi:[1,0]
    v_pk_mul_f32 v[212:213], v[212:213], v[8:9] op_sel_hi:[1,0]
    v_pk_mul_f32 v[214:215], v[214:215], v[8:9] op_sel_hi:[1,0]
    v_pk_mul_f32 v[216:217], v[216:217], v[8:9] op_sel_hi:[1,0]
    v_pk_mul_f32 v[218:219], v[218:219], v[8:9] op_sel_hi:[1,0]
    v_pk_mul_f32 v[220:221], v[220:221], v[8:9] op_sel_hi:[1,0]
    v_pk_mul_f32 v[222:223], v[222:223], v[8:9] op_sel_hi:[1,0]
    v_mfma_f32_16x16x32_bf16 v[48:51], a[116:119], a[84:87], v[48:51]
    s_waitcnt lgkmcnt(1)
    v_exp_f32 v59, v59
    v_cvt_pk_bf16_f32 v192, v192, v193
    v_cvt_pk_bf16_f32 v193, v194, v195
    v_mfma_f32_16x16x32_bf16 v[48:51], a[120:123], a[88:91], v[48:51]
    v_cvt_pk_bf16_f32 v55, v58, v59
    v_cvt_pk_bf16_f32 v194, v196, v197
    v_cvt_pk_bf16_f32 v195, v198, v199
    v_mfma_f32_16x16x32_bf16 v[48:51], a[124:127], a[92:95], v[48:51]
    ds_write_b128 v60, v[192:195] offset:4352
    v_cvt_pk_bf16_f32 v200, v200, v201
    v_cvt_pk_bf16_f32 v201, v202, v203
    v_mfma_f32_16x16x32_bf16 a[244:247], a[248:251], v[52:55], 0
    ds_read_b128 a[132:135], v2 offset:49984
    v_cvt_pk_bf16_f32 v202, v204, v205
    v_cvt_pk_bf16_f32 v203, v206, v207
    v_mfma_f32_16x16x32_bf16 v[224:227], a[160:163], v[52:55], v[224:227]
    ds_read_b128 a[136:139], v2 offset:50048
    ds_write_b128 v60, v[200:203] offset:4416
    v_cvt_pk_bf16_f32 v208, v208, v209
    v_cvt_pk_bf16_f32 v209, v210, v211
    v_mfma_f32_16x16x32_bf16 v[228:231], a[164:167], v[52:55], v[228:231]
    ds_read_b128 a[140:143], v2 offset:50112
    v_cvt_pk_bf16_f32 v210, v212, v213
    v_cvt_pk_bf16_f32 v211, v214, v215
    v_mfma_f32_16x16x32_bf16 v[232:235], a[168:171], v[52:55], v[232:235]
    ds_read_b128 a[144:147], v2 offset:50432
    ds_write_b128 v60, v[208:211] offset:4480
    v_cvt_pk_bf16_f32 v216, v216, v217
    v_cvt_pk_bf16_f32 v217, v218, v219
    v_mfma_f32_16x16x32_bf16 v[236:239], a[172:175], v[52:55], v[236:239]
    ds_read_b128 a[148:151], v2 offset:50496
    v_exp_f32 v36, v36
    v_cvt_pk_bf16_f32 v218, v220, v221
    v_cvt_pk_bf16_f32 v219, v222, v223
    v_mfma_f32_16x16x32_bf16 v[240:243], a[176:179], v[52:55], v[240:243]
    ds_read_b128 a[152:155], v2 offset:50560
    ds_write_b128 v60, v[216:219] offset:4544
    v_exp_f32 v37, v37
    v_mfma_f32_16x16x32_bf16 v[244:247], a[180:183], v[52:55], v[244:247]
    ds_read_b128 a[156:159], v2 offset:50624
    ds_read_b128 v[196:199], v61 offset:4352
    v_mfma_f32_16x16x32_bf16 v[248:251], a[184:187], v[52:55], v[248:251]
    ds_read_b128 v[204:207], v61 offset:5440
    v_exp_f32 v38, v38
    v_mfma_f32_16x16x32_bf16 v[252:255], a[188:191], v[52:55], v[252:255]
    s_waitcnt lgkmcnt(11)
    ds_read_b128 v[212:215], v61 offset:6528
    v_exp_f32 v39, v39
    v_mfma_f32_16x16x32_bf16 v[52:55], a[128:131], a[80:83], v[32:35]
    ds_read_b64_tr_b16 a[160:161], v3 offset:33280
    ds_read_b128 v[220:223], v61 offset:7616
    v_mfma_f32_16x16x32_bf16 v[52:55], a[132:135], a[84:87], v[52:55]
    s_waitcnt lgkmcnt(11)
    ds_read_b64_tr_b16 a[162:163], v3 offset:33792
    v_exp_f32 v40, v40
    v_mfma_f32_16x16x32_bf16 v[52:55], a[136:139], a[88:91], v[52:55]
    ds_read_b64_tr_b16 a[164:165], v3 offset:33288
    v_exp_f32 v41, v41
    v_mfma_f32_16x16x32_bf16 v[52:55], a[140:143], a[92:95], v[52:55]
    s_waitcnt lgkmcnt(6)
    buffer_store_dwordx4 v[196:199], v62, s[16:19], s100 offen offset:0 sc1
    ds_read_b64_tr_b16 a[166:167], v3 offset:33800
    v_cvt_pk_bf16_f32 v36, v36, v37
    v_mfma_f32_16x16x32_bf16 v[56:59], a[144:147], a[80:83], v[32:35]
    ds_read_b64_tr_b16 a[168:169], v3 offset:33344
    v_cvt_pk_bf16_f32 v37, v38, v39
    v_exp_f32 v42, v42
    v_exp_f32 v44, v44
    v_mfma_f32_16x16x32_bf16 v[56:59], a[148:151], a[84:87], v[56:59]
    ds_read_b64_tr_b16 a[170:171], v3 offset:33856
    v_cvt_pk_bf16_f32 v38, v40, v41
    v_exp_f32 v43, v43
    v_exp_f32 v45, v45
    v_mfma_f32_16x16x32_bf16 v[56:59], a[152:155], a[88:91], v[56:59]
    ds_read_b64_tr_b16 a[172:173], v3 offset:33352
    v_cvt_pk_bf16_f32 v39, v42, v43
    v_mfma_f32_16x16x32_bf16 v[56:59], a[156:159], a[92:95], v[56:59]
    ds_read_b64_tr_b16 a[174:175], v3 offset:33864
    v_exp_f32 v46, v46
    v_mfma_f32_16x16x32_bf16 a[244:247], a[248:251], v[36:39], a[244:247]
    ds_read_b64_tr_b16 a[176:177], v3 offset:33408
    v_exp_f32 v47, v47
    v_mfma_f32_16x16x32_bf16 v[224:227], a[192:195], v[36:39], v[224:227]
    ds_read_b64_tr_b16 a[178:179], v3 offset:33920
    ds_read_b64_tr_b16 a[192:193], v3 offset:49920
    v_mfma_f32_16x16x32_bf16 v[228:231], a[196:199], v[36:39], v[228:231]
    ds_read_b64_tr_b16 a[180:181], v3 offset:33416
    ds_read_b64_tr_b16 a[194:195], v3 offset:50432
    v_exp_f32 v48, v48
    v_mfma_f32_16x16x32_bf16 v[232:235], a[200:203], v[36:39], v[232:235]
    s_waitcnt lgkmcnt(9)
    buffer_store_dwordx4 v[204:207], v62, s[16:19], s100 offen offset:1024 sc1
    ds_read_b64_tr_b16 a[182:183], v3 offset:33928
    ds_read_b64_tr_b16 a[196:197], v3 offset:49928
    v_exp_f32 v49, v49
    v_mfma_f32_16x16x32_bf16 v[236:239], a[204:207], v[36:39], v[236:239]
    ds_read_b64_tr_b16 a[184:185], v3 offset:33472
    ds_read_b64_tr_b16 a[198:199], v3 offset:50440
    v_cvt_pk_bf16_f32 v44, v44, v45
    v_mfma_f32_16x16x32_bf16 v[240:243], a[208:211], v[36:39], v[240:243]
    ds_read_b64_tr_b16 a[186:187], v3 offset:33984
    ds_read_b64_tr_b16 a[200:201], v3 offset:49984
    v_cvt_pk_bf16_f32 v45, v46, v47
    v_exp_f32 v50, v50
    v_exp_f32 v52, v52
    v_mfma_f32_16x16x32_bf16 v[244:247], a[212:215], v[36:39], v[244:247]
    ds_read_b64_tr_b16 a[188:189], v3 offset:33480
    ds_read_b64_tr_b16 a[202:203], v3 offset:50496
    v_cvt_pk_bf16_f32 v46, v48, v49
    v_exp_f32 v51, v51
    v_exp_f32 v53, v53
    v_mfma_f32_16x16x32_bf16 v[248:251], a[216:219], v[36:39], v[248:251]
    ds_read_b64_tr_b16 a[190:191], v3 offset:33992
    ds_read_b64_tr_b16 a[204:205], v3 offset:49992
    v_cvt_pk_bf16_f32 v47, v50, v51
    v_mfma_f32_16x16x32_bf16 v[252:255], a[220:223], v[36:39], v[252:255]
    ds_read_b64_tr_b16 a[206:207], v3 offset:50504
    v_exp_f32 v54, v54
    v_mfma_f32_16x16x32_bf16 a[244:247], a[248:251], v[44:47], a[244:247]
    ds_read_b64_tr_b16 a[208:209], v3 offset:50048
    v_exp_f32 v55, v55
    v_mfma_f32_16x16x32_bf16 v[224:227], a[160:163], v[44:47], v[224:227]
    ds_read_b64_tr_b16 a[210:211], v3 offset:50560
    v_cvt_pk_bf16_f32 v52, v52, v53
    v_mfma_f32_16x16x32_bf16 v[228:231], a[164:167], v[44:47], v[228:231]
    s_waitcnt lgkmcnt(11)
    buffer_store_dwordx4 v[212:215], v62, s[16:19], s100 offen offset:2048 sc1
    ds_read_b64_tr_b16 a[212:213], v3 offset:50056
    v_exp_f32 v56, v56
    v_mfma_f32_16x16x32_bf16 v[232:235], a[168:171], v[44:47], v[232:235]
    ds_read_b64_tr_b16 a[214:215], v3 offset:50568
    v_exp_f32 v57, v57
    v_mfma_f32_16x16x32_bf16 v[236:239], a[172:175], v[44:47], v[236:239]
    ds_read_b64_tr_b16 a[216:217], v3 offset:50112
    v_cvt_pk_bf16_f32 v53, v54, v55
    v_mfma_f32_16x16x32_bf16 v[240:243], a[176:179], v[44:47], v[240:243]
    ds_read_b64_tr_b16 a[218:219], v3 offset:50624
    v_exp_f32 v58, v58
    v_mfma_f32_16x16x32_bf16 v[244:247], a[180:183], v[44:47], v[244:247]
    s_waitcnt lgkmcnt(7)
    ds_read_b64_tr_b16 a[220:221], v3 offset:50120
    v_cvt_pk_bf16_f32 v54, v56, v57
    v_exp_f32 v59, v59
    v_mfma_f32_16x16x32_bf16 v[248:251], a[184:187], v[44:47], v[248:251]
    ds_read_b64_tr_b16 a[222:223], v3 offset:50632
    v_cvt_pk_bf16_f32 v55, v58, v59
    v_mfma_f32_16x16x32_bf16 v[252:255], a[188:191], v[44:47], v[252:255]
    v_mov_b32 v10, v9
    v_mfma_f32_16x16x32_bf16 a[244:247], a[248:251], v[52:55], a[244:247]
    s_nop 0
    v_permlane32_swap_b32 v10, v9
    v_mfma_f32_16x16x32_bf16 v[224:227], a[192:195], v[52:55], v[224:227]
    buffer_store_dwordx4 v[220:223], v62, s[16:19], s100 offen offset:3072 sc1
    v_mfma_f32_16x16x32_bf16 v[228:231], a[196:199], v[52:55], v[228:231]
    v_add_f32 v9, v9, v10
    v_mov_b32 v10, v9
    v_mfma_f32_16x16x32_bf16 v[232:235], a[200:203], v[52:55], v[232:235]
    s_waitcnt lgkmcnt(3)
    v_permlane16_swap_b32 v10, v9
    v_mfma_f32_16x16x32_bf16 v[236:239], a[204:207], v[52:55], v[236:239]
    v_add_f32 v9, v9, v10
    v_accvgpr_read_b32 v10, a244
    v_mfma_f32_16x16x32_bf16 v[240:243], a[208:211], v[52:55], v[240:243]
    v_add_f32 v9, v9, v10
    v_cmp_nge_f32 vcc, s47, v9
    v_mfma_f32_16x16x32_bf16 v[244:247], a[212:215], v[52:55], v[244:247]
    s_waitcnt lgkmcnt(0)
    v_rcp_f32 v9, v9
    v_mfma_f32_16x16x32_bf16 v[248:251], a[216:219], v[52:55], v[248:251]
    s_and_b64 vcc, vcc, s[86:87]
    s_or_b64 s[44:45], s[44:45], vcc
    v_mfma_f32_16x16x32_bf16 v[252:255], a[220:223], v[52:55], v[252:255]
    v_pk_mul_f32 v[224:225], v[224:225], v[8:9] op_sel:[0,1]
    v_pk_mul_f32 v[226:227], v[226:227], v[8:9] op_sel:[0,1]
    v_pk_mul_f32 v[228:229], v[228:229], v[8:9] op_sel:[0,1]
    v_pk_mul_f32 v[230:231], v[230:231], v[8:9] op_sel:[0,1]
    v_cvt_pk_bf16_f32 v224, v224, v225
    v_cvt_pk_bf16_f32 v225, v226, v227
    v_cvt_pk_bf16_f32 v226, v228, v229
    v_cvt_pk_bf16_f32 v227, v230, v231
    ds_write_b128 v60, v[224:227] offset:8704
    v_pk_mul_f32 v[232:233], v[232:233], v[8:9] op_sel:[0,1]
    v_pk_mul_f32 v[234:235], v[234:235], v[8:9] op_sel:[0,1]
    v_pk_mul_f32 v[236:237], v[236:237], v[8:9] op_sel:[0,1]
    v_pk_mul_f32 v[238:239], v[238:239], v[8:9] op_sel:[0,1]
    v_cvt_pk_bf16_f32 v232, v232, v233
    v_cvt_pk_bf16_f32 v233, v234, v235
    v_cvt_pk_bf16_f32 v234, v236, v237
    v_cvt_pk_bf16_f32 v235, v238, v239
    ds_write_b128 v60, v[232:235] offset:8768
    v_pk_mul_f32 v[240:241], v[240:241], v[8:9] op_sel:[0,1]
    v_pk_mul_f32 v[242:243], v[242:243], v[8:9] op_sel:[0,1]
    v_pk_mul_f32 v[244:245], v[244:245], v[8:9] op_sel:[0,1]
    v_pk_mul_f32 v[246:247], v[246:247], v[8:9] op_sel:[0,1]
    v_cvt_pk_bf16_f32 v240, v240, v241
    v_cvt_pk_bf16_f32 v241, v242, v243
    v_cvt_pk_bf16_f32 v242, v244, v245
    v_cvt_pk_bf16_f32 v243, v246, v247
    ds_write_b128 v60, v[240:243] offset:8832
    v_pk_mul_f32 v[248:249], v[248:249], v[8:9] op_sel:[0,1]
    v_pk_mul_f32 v[250:251], v[250:251], v[8:9] op_sel:[0,1]
    v_pk_mul_f32 v[252:253], v[252:253], v[8:9] op_sel:[0,1]
    v_pk_mul_f32 v[254:255], v[254:255], v[8:9] op_sel:[0,1]
    v_cvt_pk_bf16_f32 v248, v248, v249
    v_cvt_pk_bf16_f32 v249, v250, v251
    v_cvt_pk_bf16_f32 v250, v252, v253
    v_cvt_pk_bf16_f32 v251, v254, v255
    ds_write_b128 v60, v[248:251] offset:8896
    ds_read_b128 v[228:231], v61 offset:8704
    ds_read_b128 v[236:239], v61 offset:9792
    ds_read_b128 v[244:247], v61 offset:10880
    ds_read_b128 v[252:255], v61 offset:11968
    s_waitcnt lgkmcnt(3)
    buffer_store_dwordx4 v[228:231], v62, s[16:19], s101 offen offset:0 sc1
    s_waitcnt lgkmcnt(2)
    buffer_store_dwordx4 v[236:239], v62, s[16:19], s101 offen offset:1024 sc1
    s_waitcnt lgkmcnt(1)
    buffer_store_dwordx4 v[244:247], v62, s[16:19], s101 offen offset:2048 sc1
    s_waitcnt lgkmcnt(0)
    buffer_store_dwordx4 v[252:255], v62, s[16:19], s101 offen offset:3072 sc1
    s_or_b32 s28, s44, s45
    s_lshl_b32 s29, s20, 2
    s_add_u32 s29, s29, 163776
    v_mov_b32 v10, s29
    v_mov_b32 v11, s28
    ds_write_b32 v10, v11
    v_mov_b32 v10, 163776
    s_waitcnt lgkmcnt(0)
    s_barrier
    ds_read_b128 v[12:15], v10
    s_waitcnt lgkmcnt(0)
    v_or3_b32 v12, v12, v13, v14
    v_or_b32 v12, v12, v15
    s_nop 0
    v_readfirstlane_b32 s28, v12
    s_cmp_lg_u32 s28, 0
    s_cbranch_scc1 L_slow
L_end:
    s_endpgm
L_thr0:
    s_waitcnt vmcnt(3)
    s_branch L_thrb0
L_thr1:
    s_waitcnt vmcnt(3)
    s_branch L_thrb1
L_thr2:
    s_waitcnt vmcnt(3)
    s_branch L_thrb2
L_ldr:
    s_add_u32 s23, s23, 6144
    s_mov_b32 m0, s24
    s_mov_b64 s[86:87], 0
    v_subrev_u32 v1, 6144, v1
    v_add_u32 v224, 32, v1
    v_add_u32 v225, 8, v1
    s_add_u32 s23, s23, 2048
    s_and_b32 s23, s23, 0x1ffff
    s_add_u32 s24, m0, 4160
    s_sub_u32 s28, s24, 133120
    s_cselect_b32 m0, s24, s28
    v_mfma_f32_16x16x32_bf16 v[192:195], a[160:163], v[36:39], 0
    buffer_load_dwordx4 v224, s[8:11], s23 offen nt lds
    buffer_load_dwordx4 v1, s[8:11], s23 offen offset:1056 nt lds
    buffer_load_dwordx4 v225, s[12:15], s23 offen offset:2080 nt lds
    buffer_load_dwordx4 v1, s[12:15], s23 offen offset:3112 nt lds
    v_mfma_f32_16x16x32_bf16 v[196:199], a[164:167], v[36:39], 0
    v_mfma_f32_16x16x32_bf16 v[200:203], a[168:171], v[36:39], 0
    v_mfma_f32_16x16x32_bf16 v[204:207], a[172:175], v[36:39], 0
    v_mfma_f32_16x16x32_bf16 v[208:211], a[176:179], v[36:39], 0
    v_mfma_f32_16x16x32_bf16 v[212:215], a[180:183], v[36:39], 0
    v_mfma_f32_16x16x32_bf16 v[216:219], a[184:187], v[36:39], 0
    v_mfma_f32_16x16x32_bf16 v[220:223], a[188:191], v[36:39], 0
    v_exp_f32 v44, v44
    v_exp_f32 v45, v45
    v_exp_f32 v46, v46
    s_add_u32 s23, s23, 2048
    s_and_b32 s23, s23, 0x1ffff
    s_add_u32 s24, m0, 4160
    s_sub_u32 s28, s24, 133120
    s_cselect_b32 m0, s24, s28
    v_exp_f32 v47, v47
    buffer_load_dwordx4 v224, s[8:11], s23 offen nt lds
    buffer_load_dwordx4 v1, s[8:11], s23 offen offset:1056 nt lds
    buffer_load_dwordx4 v225, s[12:15], s23 offen offset:2080 nt lds
    buffer_load_dwordx4 v1, s[12:15], s23 offen offset:3112 nt lds
    v_exp_f32 v48, v48
    v_exp_f32 v49, v49
    v_exp_f32 v50, v50
    v_exp_f32 v51, v51
    v_add_f32 v8, v8, v44
    v_add_f32 v8, v8, v45
    v_cvt_pk_bf16_f32 v44, v44, v45
    v_add_f32 v8, v8, v46
    v_add_f32 v8, v8, v47
    v_cvt_pk_bf16_f32 v45, v46, v47
    s_add_u32 s23, s23, 2048
    s_and_b32 s23, s23, 0x1ffff
    s_add_u32 s24, m0, 4160
    s_sub_u32 s28, s24, 133120
    s_cselect_b32 m0, s24, s28
    v_add_f32 v8, v8, v48
    buffer_load_dwordx4 v224, s[8:11], s23 offen nt lds
    buffer_load_dwordx4 v1, s[8:11], s23 offen offset:1056 nt lds
    buffer_load_dwordx4 v225, s[12:15], s23 offen offset:2080 nt lds
    buffer_load_dwordx4 v1, s[12:15], s23 offen offset:3112 nt lds
    v_add_f32 v8, v8, v49
    v_cvt_pk_bf16_f32 v46, v48, v49
    v_add_f32 v8, v8, v50
    v_add_f32 v8, v8, v51
    v_cvt_pk_bf16_f32 v47, v50, v51
    v_accvgpr_write_b32 a80, 0
    v_accvgpr_write_b32 a81, 0
    v_accvgpr_write_b32 a82, 0
    v_accvgpr_write_b32 a83, 0
    v_accvgpr_write_b32 a84, 0
    s_add_u32 s23, s23, 2048
    s_and_b32 s23, s23, 0x1ffff
    s_add_u32 s24, m0, 4160
    s_sub_u32 s28, s24, 133120
    s_cselect_b32 m0, s24, s28
    v_accvgpr_write_b32 a85, 0
    buffer_load_dwordx4 v224, s[8:11], s23 offen nt lds
    buffer_load_dwordx4 v1, s[8:11], s23 offen offset:1056 nt lds
    buffer_load_dwordx4 v225, s[12:15], s23 offen offset:2080 nt lds
    buffer_load_dwordx4 v1, s[12:15], s23 offen offset:3112 nt lds
    v_accvgpr_write_b32 a86, 0
    v_accvgpr_write_b32 a87, 0
    v_accvgpr_write_b32 a88, 0
    v_accvgpr_write_b32 a89, 0
    v_accvgpr_write_b32 a90, 0
    v_accvgpr_write_b32 a91, 0
    v_accvgpr_write_b32 a92, 0
    v_accvgpr_write_b32 a93, 0
    v_accvgpr_write_b32 a94, 0
    v_accvgpr_write_b32 a95, 0
    s_waitcnt vmcnt(16)
    v_mov_b32 v32, 0xff800000
    v_mov_b32 v33, 0xff800000
    v_mov_b32 v34, 0xff800000
    v_mov_b32 v35, 0xff800000
    v_mov_b32 v9, 0
    s_cbranch_vccnz L_noed
    s_waitcnt vmcnt(0)
L_noed:
    s_barrier
    s_add_u32 s23, s23, 2048
    s_and_b32 s23, s23, 0x1ffff
    s_add_u32 s24, m0, 4160
    s_sub_u32 s28, s24, 133120
    s_cselect_b32 m0, s24, s28
    ds_read_b128 a[96:99], v2 offset:0
    buffer_load_dwordx4 v224, s[8:11], s23 offen nt lds
    buffer_load_dwordx4 v1, s[8:11], s23 offen offset:1056 nt lds
    buffer_load_dwordx4 v225, s[12:15], s23 offen offset:2080 nt lds
    buffer_load_dwordx4 v1, s[12:15], s23 offen offset:3112 nt lds
    ds_read_b128 a[100:103], v2 offset:64
    ds_read_b128 a[104:107], v2 offset:128
    ds_read_b128 a[108:111], v2 offset:192
    ds_read_b128 a[112:115], v2 offset:512
    ds_read_b128 a[116:119], v2 offset:576
    ds_read_b128 a[120:123], v2 offset:640
    s_add_u32 s23, s23, 2048
    s_and_b32 s23, s23, 0x1ffff
    s_add_u32 s24, m0, 4160
    s_sub_u32 s28, s24, 133120
    s_cselect_b32 m0, s24, s28
    ds_read_b128 a[124:127], v2 offset:704
    buffer_load_dwordx4 v224, s[8:11], s23 offen nt lds
    buffer_load_dwordx4 v1, s[8:11], s23 offen offset:1056 nt lds
    buffer_load_dwordx4 v225, s[12:15], s23 offen offset:2080 nt lds
    buffer_load_dwordx4 v1, s[12:15], s23 offen offset:3112 nt lds
    ds_read_b64_tr_b16 a[160:161], v3 offset:0
    ds_read_b64_tr_b16 a[162:163], v3 offset:512
    ds_read_b64_tr_b16 a[164:165], v3 offset:8
    ds_read_b64_tr_b16 a[166:167], v3 offset:520
    ds_read_b64_tr_b16 a[168:169], v3 offset:64
    ds_read_b64_tr_b16 a[170:171], v3 offset:576
    s_add_u32 s23, s23, 2048
    s_and_b32 s23, s23, 0x1ffff
    s_add_u32 s24, m0, 4160
    s_sub_u32 s28, s24, 133120
    s_cselect_b32 m0, s24, s28
    ds_read_b64_tr_b16 a[172:173], v3 offset:72
    buffer_load_dwordx4 v224, s[8:11], s23 offen nt lds
    buffer_load_dwordx4 v1, s[8:11], s23 offen offset:1056 nt lds
    buffer_load_dwordx4 v225, s[12:15], s23 offen offset:2080 nt lds
    buffer_load_dwordx4 v1, s[12:15], s23 offen offset:3112 nt lds
    ds_read_b64_tr_b16 a[174:175], v3 offset:584
    s_waitcnt lgkmcnt(0)
.p2align 6
L_loop3:
    v_mfma_f32_16x16x32_bf16 v[36:39], a[96:99], a[0:3], v[12:15]
    v_mfma_f32_16x16x32_bf16 v[36:39], a[100:103], a[4:7], v[36:39]
    ds_read_b64_tr_b16 a[176:177], v3 offset:128
    v_mfma_f32_16x16x32_bf16 v[36:39], a[104:107], a[8:11], v[36:39]
    s_add_u32 s23, s23, 2048
    v_mfma_f32_16x16x32_bf16 v[36:39], a[108:111], a[12:15], v[36:39]
    s_and_b32 s23, s23, 0x1ffff
    v_mfma_f32_16x16x32_bf16 v[40:43], a[112:115], a[0:3], v[12:15]
    s_add_u32 s24, m0, 4160
    v_mfma_f32_16x16x32_bf16 v[40:43], a[116:119], a[4:7], v[40:43]
    s_sub_u32 s28, s24, 133120
    ds_read_b64_tr_b16 a[178:179], v3 offset:640
    v_mfma_f32_16x16x32_bf16 v[40:43], a[120:123], a[8:11], v[40:43]
    s_cselect_b32 m0, s24, s28
    v_mfma_f32_16x16x32_bf16 v[40:43], a[124:127], a[12:15], v[40:43]
    buffer_load_dwordx4 v224, s[8:11], s23 offen nt lds
    buffer_load_dwordx4 v1, s[8:11], s23 offen offset:1056 nt lds
    buffer_load_dwordx4 v225, s[12:15], s23 offen offset:2080 nt lds
    buffer_load_dwordx4 v1, s[12:15], s23 offen offset:3112 nt lds
    v_mfma_f32_16x16x32_bf16 v[192:195], a[192:195], v[44:47], v[192:195]
    v_exp_f32 v36, v36
    v_mfma_f32_16x16x32_bf16 v[196:199], a[196:199], v[44:47], v[196:199]
    ds_read_b64_tr_b16 a[180:181], v3 offset:136
    v_mfma_f32_16x16x32_bf16 v[200:203], a[200:203], v[44:47], v[200:203]
    v_exp_f32 v37, v37
    v_mfma_f32_16x16x32_bf16 v[204:207], a[204:207], v[44:47], v[204:207]
    v_exp_f32 v38, v38
    v_mfma_f32_16x16x32_bf16 v[208:211], a[208:211], v[44:47], v[208:211]
    v_exp_f32 v39, v39
    v_mfma_f32_16x16x32_bf16 v[212:215], a[212:215], v[44:47], v[212:215]
    ds_read_b64_tr_b16 a[182:183], v3 offset:648
    v_add_f32 v4, v4, v36
    v_mfma_f32_16x16x32_bf16 v[216:219], a[216:219], v[44:47], v[216:219]
    v_add_f32 v4, v4, v37
    v_cvt_pk_bf16_f32 v36, v36, v37
    v_mfma_f32_16x16x32_bf16 v[220:223], a[220:223], v[44:47], v[220:223]
    v_exp_f32 v40, v40
    v_mfma_f32_16x16x32_bf16 v[44:47], a[96:99], a[16:19], v[16:19]
    v_exp_f32 v41, v41
    v_mfma_f32_16x16x32_bf16 v[44:47], a[100:103], a[20:23], v[44:47]
    ds_read_b64_tr_b16 a[184:185], v3 offset:192
    v_add_f32 v4, v4, v38
    v_mfma_f32_16x16x32_bf16 v[44:47], a[104:107], a[24:27], v[44:47]
    v_add_f32 v4, v4, v39
    v_cvt_pk_bf16_f32 v37, v38, v39
    v_mfma_f32_16x16x32_bf16 v[44:47], a[108:111], a[28:31], v[44:47]
    v_exp_f32 v42, v42
    v_mfma_f32_16x16x32_bf16 v[48:51], a[112:115], a[16:19], v[16:19]
    v_exp_f32 v43, v43
    v_mfma_f32_16x16x32_bf16 v[48:51], a[116:119], a[20:23], v[48:51]
    ds_read_b64_tr_b16 a[186:187], v3 offset:704
    v_add_f32 v4, v4, v40
    v_mfma_f32_16x16x32_bf16 v[48:51], a[120:123], a[24:27], v[48:51]
    s_add_u32 s23, s23, 2048
    ds_read_b64_tr_b16 a[188:189], v3 offset:200
    v_add_f32 v4, v4, v41
    v_mfma_f32_16x16x32_bf16 v[48:51], a[124:127], a[28:31], v[48:51]
    s_and_b32 s23, s23, 0x1ffff
    ds_read_b64_tr_b16 a[190:191], v3 offset:712
    v_cvt_pk_bf16_f32 v38, v40, v41
    v_mfma_f32_16x16x32_bf16 v[52:55], a[96:99], a[32:35], v[20:23]
    s_waitcnt vmcnt(16)
    s_barrier
    s_add_u32 s24, m0, 4160
    v_add_f32 v4, v4, v42
    v_add_f32 v4, v4, v43
    v_mfma_f32_16x16x32_bf16 v[52:55], a[100:103], a[36:39], v[52:55]
    s_sub_u32 s28, s24, 133120
    ds_read_b128 a[128:131], v2 offset:16640
    v_cvt_pk_bf16_f32 v39, v42, v43
    v_mfma_f32_16x16x32_bf16 v[52:55], a[104:107], a[40:43], v[52:55]
    s_cselect_b32 m0, s24, s28
    v_exp_f32 v44, v44
    v_mfma_f32_16x16x32_bf16 v[52:55], a[108:111], a[44:47], v[52:55]
    buffer_load_dwordx4 v224, s[8:11], s23 offen nt lds
    buffer_load_dwordx4 v1, s[8:11], s23 offen offset:1056 nt lds
    buffer_load_dwordx4 v225, s[12:15], s23 offen offset:2080 nt lds
    buffer_load_dwordx4 v1, s[12:15], s23 offen offset:3112 nt lds
    v_mfma_f32_16x16x32_bf16 v[56:59], a[112:115], a[32:35], v[20:23]
    v_exp_f32 v45, v45
    v_mfma_f32_16x16x32_bf16 v[56:59], a[116:119], a[36:39], v[56:59]
    ds_read_b128 a[132:135], v2 offset:16704
    v_mfma_f32_16x16x32_bf16 v[56:59], a[120:123], a[40:43], v[56:59]
    v_exp_f32 v46, v46
    v_mfma_f32_16x16x32_bf16 v[56:59], a[124:127], a[44:47], v[56:59]
    s_waitcnt lgkmcnt(2)
    v_exp_f32 v47, v47
    v_mfma_f32_16x16x32_bf16 v[64:67], a[160:163], v[36:39], v[64:67]
    v_add_f32 v5, v5, v44
    v_add_f32 v5, v5, v45
    v_mfma_f32_16x16x32_bf16 v[68:71], a[164:167], v[36:39], v[68:71]
    ds_read_b128 a[136:139], v2 offset:16768
    v_cvt_pk_bf16_f32 v44, v44, v45
    v_mfma_f32_16x16x32_bf16 v[72:75], a[168:171], v[36:39], v[72:75]
    v_exp_f32 v48, v48
    v_mfma_f32_16x16x32_bf16 v[76:79], a[172:175], v[36:39], v[76:79]
    v_exp_f32 v49, v49
    v_mfma_f32_16x16x32_bf16 v[80:83], a[176:179], v[36:39], v[80:83]
    v_add_f32 v5, v5, v46
    v_add_f32 v5, v5, v47
    v_mfma_f32_16x16x32_bf16 v[84:87], a[180:183], v[36:39], v[84:87]
    ds_read_b128 a[140:143], v2 offset:16832
    v_cvt_pk_bf16_f32 v45, v46, v47
    v_mfma_f32_16x16x32_bf16 v[88:91], a[184:187], v[36:39], v[88:91]
    s_add_u32 s23, s23, 2048
    v_exp_f32 v50, v50
    v_mfma_f32_16x16x32_bf16 v[92:95], a[188:191], v[36:39], v[92:95]
    s_and_b32 s23, s23, 0x1ffff
    v_exp_f32 v51, v51
    v_mfma_f32_16x16x32_bf16 v[36:39], a[96:99], a[48:51], v[24:27]
    s_add_u32 s24, m0, 4160
    v_add_f32 v5, v5, v48
    v_add_f32 v5, v5, v49
    v_mfma_f32_16x16x32_bf16 v[36:39], a[100:103], a[52:55], v[36:39]
    s_sub_u32 s28, s24, 133120
    ds_read_b128 a[144:147], v2 offset:17152
    v_cvt_pk_bf16_f32 v46, v48, v49
    v_mfma_f32_16x16x32_bf16 v[36:39], a[104:107], a[56:59], v[36:39]
    s_cselect_b32 m0, s24, s28
    v_add_f32 v5, v5, v50
    v_add_f32 v5, v5, v51
    v_mfma_f32_16x16x32_bf16 v[36:39], a[108:111], a[60:63], v[36:39]
    buffer_load_dwordx4 v224, s[8:11], s23 offen nt lds
    buffer_load_dwordx4 v1, s[8:11], s23 offen offset:1056 nt lds
    buffer_load_dwordx4 v225, s[12:15], s23 offen offset:2080 nt lds
    buffer_load_dwordx4 v1, s[12:15], s23 offen offset:3112 nt lds
    v_mfma_f32_16x16x32_bf16 v[40:43], a[112:115], a[48:51], v[24:27]
    v_cvt_pk_bf16_f32 v47, v50, v51
    v_mfma_f32_16x16x32_bf16 v[40:43], a[116:119], a[52:55], v[40:43]
    ds_read_b128 a[148:151], v2 offset:17216
    v_mfma_f32_16x16x32_bf16 v[40:43], a[120:123], a[56:59], v[40:43]
    v_exp_f32 v52, v52
    v_mfma_f32_16x16x32_bf16 v[40:43], a[124:127], a[60:63], v[40:43]
    v_exp_f32 v53, v53
    v_mfma_f32_16x16x32_bf16 v[96:99], a[160:163], v[44:47], v[96:99]
    v_exp_f32 v54, v54
    v_mfma_f32_16x16x32_bf16 v[100:103], a[164:167], v[44:47], v[100:103]
    ds_read_b128 a[152:155], v2 offset:17280
    v_mfma_f32_16x16x32_bf16 v[104:107], a[168:171], v[44:47], v[104:107]
    v_exp_f32 v55, v55
    v_mfma_f32_16x16x32_bf16 v[108:111], a[172:175], v[44:47], v[108:111]
    v_add_f32 v6, v6, v52
    v_add_f32 v6, v6, v53
    v_mfma_f32_16x16x32_bf16 v[112:115], a[176:179], v[44:47], v[112:115]
    v_cvt_pk_bf16_f32 v52, v52, v53
    v_mfma_f32_16x16x32_bf16 v[116:119], a[180:183], v[44:47], v[116:119]
    ds_read_b128 a[156:159], v2 offset:17344
    v_mfma_f32_16x16x32_bf16 v[120:123], a[184:187], v[44:47], v[120:123]
    s_add_u32 s23, s23, 2048
    v_exp_f32 v56, v56
    v_mfma_f32_16x16x32_bf16 v[124:127], a[188:191], v[44:47], v[124:127]
    s_and_b32 s23, s23, 0x1ffff
    v_exp_f32 v57, v57
    v_mfma_f32_16x16x32_bf16 v[44:47], a[96:99], a[64:67], v[28:31]
    s_add_u32 s24, m0, 4160
    v_add_f32 v6, v6, v54
    v_add_f32 v6, v6, v55
    v_mfma_f32_16x16x32_bf16 v[44:47], a[100:103], a[68:71], v[44:47]
    s_sub_u32 s28, s24, 133120
    ds_read_b64_tr_b16 a[192:193], v3 offset:16640
    v_cvt_pk_bf16_f32 v53, v54, v55
    v_mfma_f32_16x16x32_bf16 v[44:47], a[104:107], a[72:75], v[44:47]
    s_cselect_b32 m0, s24, s28
    v_exp_f32 v58, v58
    v_mfma_f32_16x16x32_bf16 v[44:47], a[108:111], a[76:79], v[44:47]
    buffer_load_dwordx4 v224, s[8:11], s23 offen nt lds
    buffer_load_dwordx4 v1, s[8:11], s23 offen offset:1056 nt lds
    buffer_load_dwordx4 v225, s[12:15], s23 offen offset:2080 nt lds
    buffer_load_dwordx4 v1, s[12:15], s23 offen offset:3112 nt lds
    v_exp_f32 v59, v59
    v_mfma_f32_16x16x32_bf16 v[48:51], a[112:115], a[64:67], v[28:31]
    v_add_f32 v6, v6, v56
    v_add_f32 v6, v6, v57
    v_mfma_f32_16x16x32_bf16 v[48:51], a[116:119], a[68:71], v[48:51]
    ds_read_b64_tr_b16 a[194:195], v3 offset:17152
    v_cvt_pk_bf16_f32 v54, v56, v57
    v_add_f32 v6, v6, v58
    v_mfma_f32_16x16x32_bf16 v[48:51], a[120:123], a[72:75], v[48:51]
    v_add_f32 v6, v6, v59
    v_cvt_pk_bf16_f32 v55, v58, v59
    v_exp_f32 v36, v36
    v_exp_f32 v37, v37
    v_exp_f32 v38, v38
    v_exp_f32 v39, v39
    v_add_f32 v7, v7, v36
    v_add_f32 v7, v7, v37
    v_cvt_pk_bf16_f32 v36, v36, v37
    v_exp_f32 v40, v40
    v_mfma_f32_16x16x32_bf16 v[48:51], a[124:127], a[76:79], v[48:51]
    v_exp_f32 v41, v41
    v_mfma_f32_16x16x32_bf16 v[128:131], a[160:163], v[52:55], v[128:131]
    v_add_f32 v7, v7, v38
    v_add_f32 v7, v7, v39
    v_mfma_f32_16x16x32_bf16 v[132:135], a[164:167], v[52:55], v[132:135]
    ds_read_b64_tr_b16 a[196:197], v3 offset:16648
    v_cvt_pk_bf16_f32 v37, v38, v39
    v_mfma_f32_16x16x32_bf16 v[136:139], a[168:171], v[52:55], v[136:139]
    v_exp_f32 v42, v42
    v_mfma_f32_16x16x32_bf16 v[140:143], a[172:175], v[52:55], v[140:143]
    v_exp_f32 v43, v43
    v_mfma_f32_16x16x32_bf16 v[144:147], a[176:179], v[52:55], v[144:147]
    v_add_f32 v7, v7, v40
    v_add_f32 v7, v7, v41
    v_mfma_f32_16x16x32_bf16 v[148:151], a[180:183], v[52:55], v[148:151]
    ds_read_b64_tr_b16 a[198:199], v3 offset:17160
    v_cvt_pk_bf16_f32 v38, v40, v41
    v_add_f32 v7, v7, v42
    v_mfma_f32_16x16x32_bf16 v[152:155], a[184:187], v[52:55], v[152:155]
    s_add_u32 s23, s23, 2048
    ds_read_b64_tr_b16 a[200:201], v3 offset:16704
    v_add_f32 v7, v7, v43
    v_cvt_pk_bf16_f32 v39, v42, v43
    v_mfma_f32_16x16x32_bf16 v[156:159], a[188:191], v[52:55], v[156:159]
    s_and_b32 s23, s23, 0x1ffff
    ds_read_b64_tr_b16 a[202:203], v3 offset:17216
    v_mfma_f32_16x16x32_bf16 v[160:163], a[160:163], v[36:39], v[160:163]
    s_add_u32 s24, m0, 4160
    v_exp_f32 v44, v44
    v_mfma_f32_16x16x32_bf16 v[164:167], a[164:167], v[36:39], v[164:167]
    s_sub_u32 s28, s24, 133120
    ds_read_b64_tr_b16 a[204:205], v3 offset:16712
    v_mfma_f32_16x16x32_bf16 v[168:171], a[168:171], v[36:39], v[168:171]
    s_cselect_b32 m0, s24, s28
    v_exp_f32 v45, v45
    v_mfma_f32_16x16x32_bf16 v[172:175], a[172:175], v[36:39], v[172:175]
    buffer_load_dwordx4 v224, s[8:11], s23 offen nt lds
    buffer_load_dwordx4 v1, s[8:11], s23 offen offset:1056 nt lds
    buffer_load_dwordx4 v225, s[12:15], s23 offen offset:2080 nt lds
    buffer_load_dwordx4 v1, s[12:15], s23 offen offset:3112 nt lds
    v_exp_f32 v46, v46
    v_mfma_f32_16x16x32_bf16 v[176:179], a[176:179], v[36:39], v[176:179]
    v_exp_f32 v47, v47
    v_mfma_f32_16x16x32_bf16 v[180:183], a[180:183], v[36:39], v[180:183]
    ds_read_b64_tr_b16 a[206:207], v3 offset:17224
    v_add_f32 v8, v8, v44
    v_add_f32 v8, v8, v45
    v_mfma_f32_16x16x32_bf16 v[184:187], a[184:187], v[36:39], v[184:187]
    v_cvt_pk_bf16_f32 v44, v44, v45
    v_exp_f32 v48, v48
    v_mfma_f32_16x16x32_bf16 v[188:191], a[188:191], v[36:39], v[188:191]
    s_waitcnt lgkmcnt(8)
    v_exp_f32 v49, v49
    v_mfma_f32_16x16x32_bf16 v[36:39], a[128:131], a[0:3], v[12:15]
    v_add_f32 v8, v8, v46
    v_add_f32 v8, v8, v47
    v_mfma_f32_16x16x32_bf16 v[36:39], a[132:135], a[4:7], v[36:39]
    ds_read_b64_tr_b16 a[208:209], v3 offset:16768
    v_cvt_pk_bf16_f32 v45, v46, v47
    v_mfma_f32_16x16x32_bf16 v[36:39], a[136:139], a[8:11], v[36:39]
    v_exp_f32 v50, v50
    v_mfma_f32_16x16x32_bf16 v[36:39], a[140:143], a[12:15], v[36:39]
    v_exp_f32 v51, v51
    v_mfma_f32_16x16x32_bf16 v[40:43], a[144:147], a[0:3], v[12:15]
    s_add_u32 s26, s26, 33280
    v_add_f32 v8, v8, v48
    v_add_f32 v8, v8, v49
    v_mfma_f32_16x16x32_bf16 v[40:43], a[148:151], a[4:7], v[40:43]
    s_cmp_eq_u32 s26, 133120
    ds_read_b64_tr_b16 a[210:211], v3 offset:17280
    v_cvt_pk_bf16_f32 v46, v48, v49
    v_add_f32 v8, v8, v50
    v_mfma_f32_16x16x32_bf16 v[40:43], a[152:155], a[8:11], v[40:43]
    s_cselect_b32 s32, 4294867456, s46
    v_add_f32 v8, v8, v51
    v_cvt_pk_bf16_f32 v47, v50, v51
    v_mfma_f32_16x16x32_bf16 v[40:43], a[156:159], a[12:15], v[40:43]
    s_cselect_b32 s26, 0, s26
    v_mfma_f32_16x16x32_bf16 v[192:195], a[160:163], v[44:47], v[192:195]
    v_exp_f32 v36, v36
    v_mfma_f32_16x16x32_bf16 v[196:199], a[164:167], v[44:47], v[196:199]
    s_add_u32 s23, s23, 2048
    ds_read_b64_tr_b16 a[212:213], v3 offset:16776
    v_mfma_f32_16x16x32_bf16 v[200:203], a[168:171], v[44:47], v[200:203]
    s_and_b32 s23, s23, 0x1ffff
    v_exp_f32 v37, v37
    v_mfma_f32_16x16x32_bf16 v[204:207], a[172:175], v[44:47], v[204:207]
    s_add_u32 s24, m0, 4160
    v_exp_f32 v38, v38
    v_mfma_f32_16x16x32_bf16 v[208:211], a[176:179], v[44:47], v[208:211]
    s_sub_u32 s28, s24, 133120
    v_exp_f32 v39, v39
    v_mfma_f32_16x16x32_bf16 v[212:215], a[180:183], v[44:47], v[212:215]
    s_cselect_b32 m0, s24, s28
    ds_read_b64_tr_b16 a[214:215], v3 offset:17288
    v_add_f32 v4, v4, v36
    v_mfma_f32_16x16x32_bf16 v[216:219], a[184:187], v[44:47], v[216:219]
    buffer_load_dwordx4 v224, s[8:11], s23 offen nt lds
    buffer_load_dwordx4 v1, s[8:11], s23 offen offset:1056 nt lds
    buffer_load_dwordx4 v225, s[12:15], s23 offen offset:2080 nt lds
    buffer_load_dwordx4 v1, s[12:15], s23 offen offset:3112 nt lds
    v_mfma_f32_16x16x32_bf16 v[220:223], a[188:191], v[44:47], v[220:223]
    v_add_f32 v4, v4, v37
    v_cvt_pk_bf16_f32 v36, v36, v37
    v_mfma_f32_16x16x32_bf16 v[44:47], a[128:131], a[16:19], v[16:19]
    v_exp_f32 v40, v40
    v_mfma_f32_16x16x32_bf16 v[44:47], a[132:135], a[20:23], v[44:47]
    ds_read_b64_tr_b16 a[216:217], v3 offset:16832
    v_mfma_f32_16x16x32_bf16 v[44:47], a[136:139], a[24:27], v[44:47]
    v_exp_f32 v41, v41
    v_mfma_f32_16x16x32_bf16 v[44:47], a[140:143], a[28:31], v[44:47]
    v_add_f32 v4, v4, v38
    v_add_f32 v4, v4, v39
    v_mfma_f32_16x16x32_bf16 v[48:51], a[144:147], a[16:19], v[16:19]
    v_cvt_pk_bf16_f32 v37, v38, v39
    v_mfma_f32_16x16x32_bf16 v[48:51], a[148:151], a[20:23], v[48:51]
    ds_read_b64_tr_b16 a[218:219], v3 offset:17344
    v_mfma_f32_16x16x32_bf16 v[48:51], a[152:155], a[24:27], v[48:51]
    ds_read_b64_tr_b16 a[220:221], v3 offset:16840
    v_add_u32 v2, s32, v2
    v_mfma_f32_16x16x32_bf16 v[48:51], a[156:159], a[28:31], v[48:51]
    ds_read_b64_tr_b16 a[222:223], v3 offset:17352
    v_mfma_f32_16x16x32_bf16 v[52:55], a[128:131], a[32:35], v[20:23]
    s_waitcnt vmcnt(20)
    s_barrier
    v_exp_f32 v42, v42
    v_mfma_f32_16x16x32_bf16 v[52:55], a[132:135], a[36:39], v[52:55]
    s_add_u32 s23, s23, 2048
    ds_read_b128 a[96:99], v2 offset:0
    v_mfma_f32_16x16x32_bf16 v[52:55], a[136:139], a[40:43], v[52:55]
    s_and_b32 s23, s23, 0x1ffff
    v_exp_f32 v43, v43
    v_mfma_f32_16x16x32_bf16 v[52:55], a[140:143], a[44:47], v[52:55]
    s_add_u32 s24, m0, 4160
    v_add_f32 v4, v4, v40
    v_add_f32 v4, v4, v41
    v_mfma_f32_16x16x32_bf16 v[56:59], a[144:147], a[32:35], v[20:23]
    s_sub_u32 s28, s24, 133120
    v_cvt_pk_bf16_f32 v38, v40, v41
    v_add_f32 v4, v4, v42
    v_mfma_f32_16x16x32_bf16 v[56:59], a[148:151], a[36:39], v[56:59]
    s_cselect_b32 m0, s24, s28
    ds_read_b128 a[100:103], v2 offset:64
    v_add_f32 v4, v4, v43
    v_mfma_f32_16x16x32_bf16 v[56:59], a[152:155], a[40:43], v[56:59]
    buffer_load_dwordx4 v224, s[8:11], s23 offen nt lds
    buffer_load_dwordx4 v1, s[8:11], s23 offen offset:1056 nt lds
    buffer_load_dwordx4 v225, s[12:15], s23 offen offset:2080 nt lds
    buffer_load_dwordx4 v1, s[12:15], s23 offen offset:3112 nt lds
    v_cvt_pk_bf16_f32 v39, v42, v43
    v_mfma_f32_16x16x32_bf16 v[56:59], a[156:159], a[44:47], v[56:59]
    s_waitcnt lgkmcnt(2)
    v_exp_f32 v44, v44
    v_mfma_f32_16x16x32_bf16 v[64:67], a[192:195], v[36:39], v[64:67]
    v_exp_f32 v45, v45
    v_mfma_f32_16x16x32_bf16 v[68:71], a[196:199], v[36:39], v[68:71]
    ds_read_b128 a[104:107], v2 offset:128
    v_mfma_f32_16x16x32_bf16 v[72:75], a[200:203], v[36:39], v[72:75]
    v_exp_f32 v46, v46
    v_mfma_f32_16x16x32_bf16 v[76:79], a[204:207], v[36:39], v[76:79]
    v_exp_f32 v47, v47
    v_mfma_f32_16x16x32_bf16 v[80:83], a[208:211], v[36:39], v[80:83]
    v_add_f32 v5, v5, v44
    v_add_f32 v5, v5, v45
    v_mfma_f32_16x16x32_bf16 v[84:87], a[212:215], v[36:39], v[84:87]
    ds_read_b128 a[108:111], v2 offset:192
    v_cvt_pk_bf16_f32 v44, v44, v45
    v_mfma_f32_16x16x32_bf16 v[88:91], a[216:219], v[36:39], v[88:91]
    v_add_u32 v3, s32, v3
    v_exp_f32 v48, v48
    v_mfma_f32_16x16x32_bf16 v[92:95], a[220:223], v[36:39], v[92:95]
    v_exp_f32 v49, v49
    v_mfma_f32_16x16x32_bf16 v[36:39], a[128:131], a[48:51], v[24:27]
    s_add_u32 s22, s22, 1
    v_add_f32 v5, v5, v46
    v_add_f32 v5, v5, v47
    v_mfma_f32_16x16x32_bf16 v[36:39], a[132:135], a[52:55], v[36:39]
    s_add_u32 s23, s23, 2048
    ds_read_b128 a[112:115], v2 offset:512
    v_cvt_pk_bf16_f32 v45, v46, v47
    v_mfma_f32_16x16x32_bf16 v[36:39], a[136:139], a[56:59], v[36:39]
    s_and_b32 s23, s23, 0x1ffff
    v_exp_f32 v50, v50
    v_mfma_f32_16x16x32_bf16 v[36:39], a[140:143], a[60:63], v[36:39]
    s_add_u32 s24, m0, 4160
    v_exp_f32 v51, v51
    v_mfma_f32_16x16x32_bf16 v[40:43], a[144:147], a[48:51], v[24:27]
    s_sub_u32 s28, s24, 133120
    v_add_f32 v5, v5, v48
    v_add_f32 v5, v5, v49
    v_mfma_f32_16x16x32_bf16 v[40:43], a[148:151], a[52:55], v[40:43]
    s_cselect_b32 m0, s24, s28
    ds_read_b128 a[116:119], v2 offset:576
    v_cvt_pk_bf16_f32 v46, v48, v49
    v_add_f32 v5, v5, v50
    v_mfma_f32_16x16x32_bf16 v[40:43], a[152:155], a[56:59], v[40:43]
    buffer_load_dwordx4 v224, s[8:11], s23 offen nt lds
    buffer_load_dwordx4 v1, s[8:11], s23 offen offset:1056 nt lds
    buffer_load_dwordx4 v225, s[12:15], s23 offen offset:2080 nt lds
    buffer_load_dwordx4 v1, s[12:15], s23 offen offset:3112 nt lds
    v_add_f32 v5, v5, v51
    v_cvt_pk_bf16_f32 v47, v50, v51
    v_mfma_f32_16x16x32_bf16 v[40:43], a[156:159], a[60:63], v[40:43]
    v_exp_f32 v52, v52
    v_mfma_f32_16x16x32_bf16 v[96:99], a[192:195], v[44:47], v[96:99]
    v_exp_f32 v53, v53
    v_mfma_f32_16x16x32_bf16 v[100:103], a[196:199], v[44:47], v[100:103]
    ds_read_b128 a[120:123], v2 offset:640
    v_mfma_f32_16x16x32_bf16 v[104:107], a[200:203], v[44:47], v[104:107]
    v_exp_f32 v54, v54
    v_mfma_f32_16x16x32_bf16 v[108:111], a[204:207], v[44:47], v[108:111]
    v_exp_f32 v55, v55
    v_mfma_f32_16x16x32_bf16 v[112:115], a[208:211], v[44:47], v[112:115]
    v_add_f32 v6, v6, v52
    v_add_f32 v6, v6, v53
    v_mfma_f32_16x16x32_bf16 v[116:119], a[212:215], v[44:47], v[116:119]
    ds_read_b128 a[124:127], v2 offset:704
    v_cvt_pk_bf16_f32 v52, v52, v53
    v_mfma_f32_16x16x32_bf16 v[120:123], a[216:219], v[44:47], v[120:123]
    v_exp_f32 v56, v56
    v_mfma_f32_16x16x32_bf16 v[124:127], a[220:223], v[44:47], v[124:127]
    s_add_u32 s23, s23, 2048
    v_exp_f32 v57, v57
    v_mfma_f32_16x16x32_bf16 v[44:47], a[128:131], a[64:67], v[28:31]
    s_and_b32 s23, s23, 0x1ffff
    v_add_f32 v6, v6, v54
    v_add_f32 v6, v6, v55
    v_mfma_f32_16x16x32_bf16 v[44:47], a[132:135], a[68:71], v[44:47]
    s_add_u32 s24, m0, 4160
    ds_read_b64_tr_b16 a[160:161], v3 offset:0
    v_cvt_pk_bf16_f32 v53, v54, v55
    v_mfma_f32_16x16x32_bf16 v[44:47], a[136:139], a[72:75], v[44:47]
    s_sub_u32 s28, s24, 133120
    v_exp_f32 v58, v58
    v_mfma_f32_16x16x32_bf16 v[44:47], a[140:143], a[76:79], v[44:47]
    s_cselect_b32 m0, s24, s28
    v_exp_f32 v59, v59
    v_mfma_f32_16x16x32_bf16 v[48:51], a[144:147], a[64:67], v[28:31]
    buffer_load_dwordx4 v224, s[8:11], s23 offen nt lds
    buffer_load_dwordx4 v1, s[8:11], s23 offen offset:1056 nt lds
    buffer_load_dwordx4 v225, s[12:15], s23 offen offset:2080 nt lds
    buffer_load_dwordx4 v1, s[12:15], s23 offen offset:3112 nt lds
    v_add_f32 v6, v6, v56
    v_add_f32 v6, v6, v57
    v_mfma_f32_16x16x32_bf16 v[48:51], a[148:151], a[68:71], v[48:51]
    ds_read_b64_tr_b16 a[162:163], v3 offset:512
    v_cvt_pk_bf16_f32 v54, v56, v57
    v_add_f32 v6, v6, v58
    v_mfma_f32_16x16x32_bf16 v[48:51], a[152:155], a[72:75], v[48:51]
    v_add_f32 v6, v6, v59
    v_cvt_pk_bf16_f32 v55, v58, v59
    v_exp_f32 v36, v36
    v_exp_f32 v37, v37
    v_exp_f32 v38, v38
    v_exp_f32 v39, v39
    v_add_f32 v7, v7, v36
    v_add_f32 v7, v7, v37
    v_cvt_pk_bf16_f32 v36, v36, v37
    v_exp_f32 v40, v40
    v_mfma_f32_16x16x32_bf16 v[48:51], a[156:159], a[76:79], v[48:51]
    v_exp_f32 v41, v41
    v_mfma_f32_16x16x32_bf16 v[128:131], a[192:195], v[52:55], v[128:131]
    v_add_f32 v7, v7, v38
    v_add_f32 v7, v7, v39
    v_mfma_f32_16x16x32_bf16 v[132:135], a[196:199], v[52:55], v[132:135]
    ds_read_b64_tr_b16 a[164:165], v3 offset:8
    v_cvt_pk_bf16_f32 v37, v38, v39
    v_mfma_f32_16x16x32_bf16 v[136:139], a[200:203], v[52:55], v[136:139]
    v_exp_f32 v42, v42
    v_mfma_f32_16x16x32_bf16 v[140:143], a[204:207], v[52:55], v[140:143]
    v_exp_f32 v43, v43
    v_mfma_f32_16x16x32_bf16 v[144:147], a[208:211], v[52:55], v[144:147]
    v_add_f32 v7, v7, v40
    v_add_f32 v7, v7, v41
    v_mfma_f32_16x16x32_bf16 v[148:151], a[212:215], v[52:55], v[148:151]
    ds_read_b64_tr_b16 a[166:167], v3 offset:520
    v_cvt_pk_bf16_f32 v38, v40, v41
    v_add_f32 v7, v7, v42
    v_mfma_f32_16x16x32_bf16 v[152:155], a[216:219], v[52:55], v[152:155]
    ds_read_b64_tr_b16 a[168:169], v3 offset:64
    v_add_f32 v7, v7, v43
    v_cvt_pk_bf16_f32 v39, v42, v43
    v_exp_f32 v44, v44
    v_exp_f32 v45, v45
    v_exp_f32 v46, v46
    v_exp_f32 v47, v47
    v_add_f32 v8, v8, v44
    v_add_f32 v8, v8, v45
    v_mfma_f32_16x16x32_bf16 v[156:159], a[220:223], v[52:55], v[156:159]
    ds_read_b64_tr_b16 a[170:171], v3 offset:576
    v_cvt_pk_bf16_f32 v44, v44, v45
    v_exp_f32 v48, v48
    v_mfma_f32_16x16x32_bf16 v[160:163], a[192:195], v[36:39], v[160:163]
    v_exp_f32 v49, v49
    v_mfma_f32_16x16x32_bf16 v[164:167], a[196:199], v[36:39], v[164:167]
    ds_read_b64_tr_b16 a[172:173], v3 offset:72
    v_add_f32 v8, v8, v46
    v_mfma_f32_16x16x32_bf16 v[168:171], a[200:203], v[36:39], v[168:171]
    v_add_f32 v8, v8, v47
    v_cvt_pk_bf16_f32 v45, v46, v47
    v_mfma_f32_16x16x32_bf16 v[172:175], a[204:207], v[36:39], v[172:175]
    v_exp_f32 v50, v50
    v_mfma_f32_16x16x32_bf16 v[176:179], a[208:211], v[36:39], v[176:179]
    v_exp_f32 v51, v51
    v_mfma_f32_16x16x32_bf16 v[180:183], a[212:215], v[36:39], v[180:183]
    ds_read_b64_tr_b16 a[174:175], v3 offset:584
    v_add_f32 v8, v8, v48
    v_add_f32 v8, v8, v49
    v_mfma_f32_16x16x32_bf16 v[184:187], a[216:219], v[36:39], v[184:187]
    s_cmp_lt_u32 s22, 6
    v_cvt_pk_bf16_f32 v46, v48, v49
    v_add_f32 v8, v8, v50
    v_mfma_f32_16x16x32_bf16 v[188:191], a[220:223], v[36:39], v[188:191]
    s_waitcnt lgkmcnt(8)
    v_add_f32 v8, v8, v51
    v_cvt_pk_bf16_f32 v47, v50, v51
    s_cbranch_scc1 L_loop3
    v_mov_b32 v52, 0
    v_mov_b32 v53, 0
    v_mov_b32 v54, 0
    v_mov_b32 v55, 0
    v_mov_b32 v56, 0
    v_mov_b32 v57, 0
    v_mov_b32 v58, 0
    v_mov_b32 v59, 0
    s_branch L_ending
L_slow:
    s_waitcnt vmcnt(0)
    v_lshrrev_b32 v60, 6, v0
    v_and_b32 v61, 63, v0
    v_lshlrev_b32 v62, 11, v60
    v_lshl_add_u32 v1, v61, 4, v62
    v_bfe_u32 v10, v0, 1, 2
    v_mul_u32_u24 v2, 4160, v10
    v_and_b32 v10, 1, v0
    v_mul_u32_u24 v10, 1056, v10
    v_add_u32 v2, v2, v10
    v_bfe_u32 v10, v0, 3, 1
    v_lshl_add_u32 v2, v10, 8, v2
    v_bfe_u32 v10, v0, 4, 2
    v_lshl_add_u32 v2, v10, 4, v2
    v_bfe_u32 v10, v0, 3, 2
    v_mul_u32_u24 v3, 4160, v10
    v_bfe_u32 v10, v0, 2, 1
    v_mul_u32_u24 v10, 1032, v10
    v_add_u32 v3, v3, v10
    v_bfe_u32 v10, v0, 5, 1
    v_lshl_add_u32 v3, v10, 8, v3
    v_and_b32 v10, 3, v0
    v_lshl_add_u32 v3, v10, 4, v3
    v_add_u32 v3, 2080, v3
    v_mov_b32 v64, 0
    v_mov_b32 v65, 0
    v_mov_b32 v66, 0
    v_mov_b32 v67, 0
    v_mov_b32 v68, 0
    v_mov_b32 v69, 0
    v_mov_b32 v70, 0
    v_mov_b32 v71, 0
    v_mov_b32 v72, 0
    v_mov_b32 v73, 0
    v_mov_b32 v74, 0
    v_mov_b32 v75, 0
    v_mov_b32 v76, 0
    v_mov_b32 v77, 0
    v_mov_b32 v78, 0
    v_mov_b32 v79, 0
    v_mov_b32 v80, 0
    v_mov_b32 v81, 0
    v_mov_b32 v82, 0
    v_mov_b32 v83, 0
    v_mov_b32 v84, 0
    v_mov_b32 v85, 0
    v_mov_b32 v86, 0
    v_mov_b32 v87, 0
    v_mov_b32 v88, 0
    v_mov_b32 v89, 0
    v_mov_b32 v90, 0
    v_mov_b32 v91, 0
    v_mov_b32 v92, 0
    v_mov_b32 v93, 0
    v_mov_b32 v94, 0
    v_mov_b32 v95, 0
    v_mov_b32 v96, 0
    v_mov_b32 v97, 0
    v_mov_b32 v98, 0
    v_mov_b32 v99, 0
    v_mov_b32 v100, 0
    v_mov_b32 v101, 0
    v_mov_b32 v102, 0
    v_mov_b32 v103, 0
    v_mov_b32 v104, 0
    v_mov_b32 v105, 0
    v_mov_b32 v106, 0
    v_mov_b32 v107, 0
    v_mov_b32 v108, 0
    v_mov_b32 v109, 0
    v_mov_b32 v110, 0
    v_mov_b32 v111, 0
    v_mov_b32 v112, 0
    v_mov_b32 v113, 0
    v_mov_b32 v114, 0
    v_mov_b32 v115, 0
    v_mov_b32 v116, 0
    v_mov_b32 v117, 0
    v_mov_b32 v118, 0
    v_mov_b32 v119, 0
    v_mov_b32 v120, 0
    v_mov_b32 v121, 0
    v_mov_b32 v122, 0
    v_mov_b32 v123, 0
    v_mov_b32 v124, 0
    v_mov_b32 v125, 0
    v_mov_b32 v126, 0
    v_mov_b32 v127, 0
    v_mov_b32 v128, 0
    v_mov_b32 v129, 0
    v_mov_b32 v130, 0
    v_mov_b32 v131, 0
    v_mov_b32 v132, 0
    v_mov_b32 v133, 0
    v_mov_b32 v134, 0
    v_mov_b32 v135, 0
    v_mov_b32 v136, 0
    v_mov_b32 v137, 0
    v_mov_b32 v138, 0
    v_mov_b32 v139, 0
    v_mov_b32 v140, 0
    v_mov_b32 v141, 0
    v_mov_b32 v142, 0
    v_mov_b32 v143, 0
    v_mov_b32 v144, 0
    v_mov_b32 v145, 0
    v_mov_b32 v146, 0
    v_mov_b32 v147, 0
    v_mov_b32 v148, 0
    v_mov_b32 v149, 0
    v_mov_b32 v150, 0
    v_mov_b32 v151, 0
    v_mov_b32 v152, 0
    v_mov_b32 v153, 0
    v_mov_b32 v154, 0
    v_mov_b32 v155, 0
    v_mov_b32 v156, 0
    v_mov_b32 v157, 0
    v_mov_b32 v158, 0
    v_mov_b32 v159, 0
    v_mov_b32 v160, 0
    v_mov_b32 v161, 0
    v_mov_b32 v162, 0
    v_mov_b32 v163, 0
    v_mov_b32 v164, 0
    v_mov_b32 v165, 0
    v_mov_b32 v166, 0
    v_mov_b32 v167, 0
    v_mov_b32 v168, 0
    v_mov_b32 v169, 0
    v_mov_b32 v170, 0
    v_mov_b32 v171, 0
    v_mov_b32 v172, 0
    v_mov_b32 v173, 0
    v_mov_b32 v174, 0
    v_mov_b32 v175, 0
    v_mov_b32 v176, 0
    v_mov_b32 v177, 0
    v_mov_b32 v178, 0
    v_mov_b32 v179, 0
    v_mov_b32 v180, 0
    v_mov_b32 v181, 0
    v_mov_b32 v182, 0
    v_mov_b32 v183, 0
    v_mov_b32 v184, 0
    v_mov_b32 v185, 0
    v_mov_b32 v186, 0
    v_mov_b32 v187, 0
    v_mov_b32 v188, 0
    v_mov_b32 v189, 0
    v_mov_b32 v190, 0
    v_mov_b32 v191, 0
    v_mov_b32 v192, 0
    v_mov_b32 v193, 0
    v_mov_b32 v194, 0
    v_mov_b32 v195, 0
    v_mov_b32 v196, 0
    v_mov_b32 v197, 0
    v_mov_b32 v198, 0
    v_mov_b32 v199, 0
    v_mov_b32 v200, 0
    v_mov_b32 v201, 0
    v_mov_b32 v202, 0
    v_mov_b32 v203, 0
    v_mov_b32 v204, 0
    v_mov_b32 v205, 0
    v_mov_b32 v206, 0
    v_mov_b32 v207, 0
    v_mov_b32 v208, 0
    v_mov_b32 v209, 0
    v_mov_b32 v210, 0
    v_mov_b32 v211, 0
    v_mov_b32 v212, 0
    v_mov_b32 v213, 0
    v_mov_b32 v214, 0
    v_mov_b32 v215, 0
    v_mov_b32 v216, 0
    v_mov_b32 v217, 0
    v_mov_b32 v218, 0
    v_mov_b32 v219, 0
    v_mov_b32 v220, 0
    v_mov_b32 v221, 0
    v_mov_b32 v222, 0
    v_mov_b32 v223, 0
    v_mov_b32 v224, 0
    v_mov_b32 v225, 0
    v_mov_b32 v226, 0
    v_mov_b32 v227, 0
    v_mov_b32 v228, 0
    v_mov_b32 v229, 0
    v_mov_b32 v230, 0
    v_mov_b32 v231, 0
    v_mov_b32 v232, 0
    v_mov_b32 v233, 0
    v_mov_b32 v234, 0
    v_mov_b32 v235, 0
    v_mov_b32 v236, 0
    v_mov_b32 v237, 0
    v_mov_b32 v238, 0
    v_mov_b32 v239, 0
    v_mov_b32 v240, 0
    v_mov_b32 v241, 0
    v_mov_b32 v242, 0
    v_mov_b32 v243, 0
    v_mov_b32 v244, 0
    v_mov_b32 v245, 0
    v_mov_b32 v246, 0
    v_mov_b32 v247, 0
    v_mov_b32 v248, 0
    v_mov_b32 v249, 0
    v_mov_b32 v250, 0
    v_mov_b32 v251, 0
    v_mov_b32 v252, 0
    v_mov_b32 v253, 0
    v_mov_b32 v254, 0
    v_mov_b32 v255, 0
    v_mov_b32 v4, 0
    v_mov_b32 v12, 0xff800000
    v_mov_b32 v5, 0
    v_mov_b32 v13, 0xff800000
    v_mov_b32 v6, 0
    v_mov_b32 v14, 0xff800000
    v_mov_b32 v7, 0
    v_mov_b32 v15, 0xff800000
    v_mov_b32 v8, 0
    v_mov_b32 v16, 0xff800000
    v_mov_b32 v9, 0
    v_mov_b32 v17, 0xff800000
    s_mov_b32 s23, 0
    s_mov_b32 s25, 32
    s_mov_b32 s3, 8
    s_mov_b32 s22, 0
L_slow_tile:
    s_barrier
    s_mov_b32 s24, s27
    s_mov_b32 m0, s24
    s_nop 0
    buffer_load_dwordx4 v1, s[8:11], s25 offen nt lds
    buffer_load_dwordx4 v1, s[8:11], s23 offen offset:1056 nt lds
    buffer_load_dwordx4 v1, s[12:15], s3 offen offset:2080 nt lds
    buffer_load_dwordx4 v1, s[12:15], s23 offen offset:3112 nt lds
    s_add_u32 s24, s24, 16640
    s_add_u32 s23, s23, 8192
    s_and_b32 s23, s23, 0x1ffff
    s_add_u32 s25, s23, 32
    s_add_u32 s3, s23, 8
    s_mov_b32 m0, s24
    s_nop 0
    buffer_load_dwordx4 v1, s[8:11], s25 offen nt lds
    buffer_load_dwordx4 v1, s[8:11], s23 offen offset:1056 nt lds
    buffer_load_dwordx4 v1, s[12:15], s3 offen offset:2080 nt lds
    buffer_load_dwordx4 v1, s[12:15], s23 offen offset:3112 nt lds
    s_add_u32 s24, s24, 16640
    s_add_u32 s23, s23, 8192
    s_and_b32 s23, s23, 0x1ffff
    s_add_u32 s25, s23, 32
    s_add_u32 s3, s23, 8
    s_waitcnt vmcnt(0)
    s_barrier
    ds_read_b128 a[96:99], v2 offset:0
    ds_read_b128 a[100:103], v2 offset:64
    ds_read_b128 a[104:107], v2 offset:128
    ds_read_b128 a[108:111], v2 offset:192
    ds_read_b128 a[112:115], v2 offset:512
    ds_read_b128 a[116:119], v2 offset:576
    ds_read_b128 a[120:123], v2 offset:640
    ds_read_b128 a[124:127], v2 offset:704
    ds_read_b128 a[128:131], v2 offset:16640
    ds_read_b128 a[132:135], v2 offset:16704
    ds_read_b128 a[136:139], v2 offset:16768
    ds_read_b128 a[140:143], v2 offset:16832
    ds_read_b128 a[144:147], v2 offset:17152
    ds_read_b128 a[148:151], v2 offset:17216
    ds_read_b128 a[152:155], v2 offset:17280
    ds_read_b128 a[156:159], v2 offset:17344
    s_waitcnt lgkmcnt(0)
    ds_read_b64_tr_b16 a[160:161], v3 offset:0
    ds_read_b64_tr_b16 a[162:163], v3 offset:512
    ds_read_b64_tr_b16 a[164:165], v3 offset:8
    ds_read_b64_tr_b16 a[166:167], v3 offset:520
    ds_read_b64_tr_b16 a[168:169], v3 offset:64
    ds_read_b64_tr_b16 a[170:171], v3 offset:576
    ds_read_b64_tr_b16 a[172:173], v3 offset:72
    ds_read_b64_tr_b16 a[174:175], v3 offset:584
    ds_read_b64_tr_b16 a[176:177], v3 offset:128
    ds_read_b64_tr_b16 a[178:179], v3 offset:640
    ds_read_b64_tr_b16 a[180:181], v3 offset:136
    ds_read_b64_tr_b16 a[182:183], v3 offset:648
    ds_read_b64_tr_b16 a[184:185], v3 offset:192
    ds_read_b64_tr_b16 a[186:187], v3 offset:704
    ds_read_b64_tr_b16 a[188:189], v3 offset:200
    ds_read_b64_tr_b16 a[190:191], v3 offset:712
    s_waitcnt lgkmcnt(0)
    ds_read_b64_tr_b16 a[192:193], v3 offset:16640
    ds_read_b64_tr_b16 a[194:195], v3 offset:17152
    ds_read_b64_tr_b16 a[196:197], v3 offset:16648
    ds_read_b64_tr_b16 a[198:199], v3 offset:17160
    ds_read_b64_tr_b16 a[200:201], v3 offset:16704
    ds_read_b64_tr_b16 a[202:203], v3 offset:17216
    ds_read_b64_tr_b16 a[204:205], v3 offset:16712
    ds_read_b64_tr_b16 a[206:207], v3 offset:17224
    ds_read_b64_tr_b16 a[208:209], v3 offset:16768
    ds_read_b64_tr_b16 a[210:211], v3 offset:17280
    ds_read_b64_tr_b16 a[212:213], v3 offset:16776
    ds_read_b64_tr_b16 a[214:215], v3 offset:17288
    ds_read_b64_tr_b16 a[216:217], v3 offset:16832
    ds_read_b64_tr_b16 a[218:219], v3 offset:17344
    ds_read_b64_tr_b16 a[220:221], v3 offset:16840
    ds_read_b64_tr_b16 a[222:223], v3 offset:17352
    s_waitcnt lgkmcnt(0)
    v_mfma_f32_16x16x32_bf16 v[36:39], a[96:99], a[0:3], 0
    v_mfma_f32_16x16x32_bf16 v[36:39], a[100:103], a[4:7], v[36:39]
    v_mfma_f32_16x16x32_bf16 v[36:39], a[104:107], a[8:11], v[36:39]
    v_mfma_f32_16x16x32_bf16 v[36:39], a[108:111], a[12:15], v[36:39]
    v_mfma_f32_16x16x32_bf16 v[40:43], a[112:115], a[0:3], 0
    v_mfma_f32_16x16x32_bf16 v[40:43], a[116:119], a[4:7], v[40:43]
    v_mfma_f32_16x16x32_bf16 v[40:43], a[120:123], a[8:11], v[40:43]
    v_mfma_f32_16x16x32_bf16 v[40:43], a[124:127], a[12:15], v[40:43]
    v_mfma_f32_16x16x32_bf16 v[44:47], a[128:131], a[0:3], 0
    v_mfma_f32_16x16x32_bf16 v[44:47], a[132:135], a[4:7], v[44:47]
    v_mfma_f32_16x16x32_bf16 v[44:47], a[136:139], a[8:11], v[44:47]
    v_mfma_f32_16x16x32_bf16 v[44:47], a[140:143], a[12:15], v[44:47]
    v_mfma_f32_16x16x32_bf16 v[48:51], a[144:147], a[0:3], 0
    v_mfma_f32_16x16x32_bf16 v[48:51], a[148:151], a[4:7], v[48:51]
    v_mfma_f32_16x16x32_bf16 v[48:51], a[152:155], a[8:11], v[48:51]
    v_mfma_f32_16x16x32_bf16 v[48:51], a[156:159], a[12:15], v[48:51]
    s_nop 7
    v_max3_f32 v10, v36, v37, v38
    v_max3_f32 v10, v10, v39, v40
    v_max3_f32 v10, v10, v41, v42
    v_max3_f32 v10, v10, v43, v44
    v_max3_f32 v10, v10, v45, v46
    v_max3_f32 v10, v10, v47, v48
    v_max3_f32 v10, v10, v49, v50
    v_max3_f32 v10, v10, v51, v12
    v_mov_b32 v11, v10
    s_nop 1
    v_permlane32_swap_b32 v11, v10
    v_max_f32 v10, v10, v11
    v_mov_b32 v11, v10
    s_nop 1
    v_permlane16_swap_b32 v11, v10
    v_max_f32 v10, v10, v11
    v_sub_f32 v20, v12, v10
    v_exp_f32 v20, v20
    v_mov_b32 v12, v10
    v_sub_f32 v36, v36, v10
    v_sub_f32 v37, v37, v10
    v_sub_f32 v38, v38, v10
    v_sub_f32 v39, v39, v10
    v_sub_f32 v40, v40, v10
    v_sub_f32 v41, v41, v10
    v_sub_f32 v42, v42, v10
    v_sub_f32 v43, v43, v10
    v_sub_f32 v44, v44, v10
    v_sub_f32 v45, v45, v10
    v_sub_f32 v46, v46, v10
    v_sub_f32 v47, v47, v10
    v_sub_f32 v48, v48, v10
    v_sub_f32 v49, v49, v10
    v_sub_f32 v50, v50, v10
    v_sub_f32 v51, v51, v10
    v_exp_f32 v36, v36
    v_exp_f32 v37, v37
    v_exp_f32 v38, v38
    v_exp_f32 v39, v39
    v_exp_f32 v40, v40
    v_exp_f32 v41, v41
    v_exp_f32 v42, v42
    v_exp_f32 v43, v43
    v_exp_f32 v44, v44
    v_exp_f32 v45, v45
    v_exp_f32 v46, v46
    v_exp_f32 v47, v47
    v_exp_f32 v48, v48
    v_exp_f32 v49, v49
    v_exp_f32 v50, v50
    v_exp_f32 v51, v51
    v_mul_f32 v4, v4, v20
    v_add_f32 v4, v4, v36
    v_add_f32 v4, v4, v37
    v_add_f32 v4, v4, v38
    v_add_f32 v4, v4, v39
    v_add_f32 v4, v4, v40
    v_add_f32 v4, v4, v41
    v_add_f32 v4, v4, v42
    v_add_f32 v4, v4, v43
    v_add_f32 v4, v4, v44
    v_add_f32 v4, v4, v45
    v_add_f32 v4, v4, v46
    v_add_f32 v4, v4, v47
    v_add_f32 v4, v4, v48
    v_add_f32 v4, v4, v49
    v_add_f32 v4, v4, v50
    v_add_f32 v4, v4, v51
    v_mul_f32 v64, v64, v20
    v_mul_f32 v65, v65, v20
    v_mul_f32 v66, v66, v20
    v_mul_f32 v67, v67, v20
    v_mul_f32 v68, v68, v20
    v_mul_f32 v69, v69, v20
    v_mul_f32 v70, v70, v20
    v_mul_f32 v71, v71, v20
    v_mul_f32 v72, v72, v20
    v_mul_f32 v73, v73, v20
    v_mul_f32 v74, v74, v20
    v_mul_f32 v75, v75, v20
    v_mul_f32 v76, v76, v20
    v_mul_f32 v77, v77, v20
    v_mul_f32 v78, v78, v20
    v_mul_f32 v79, v79, v20
    v_mul_f32 v80, v80, v20
    v_mul_f32 v81, v81, v20
    v_mul_f32 v82, v82, v20
    v_mul_f32 v83, v83, v20
    v_mul_f32 v84, v84, v20
    v_mul_f32 v85, v85, v20
    v_mul_f32 v86, v86, v20
    v_mul_f32 v87, v87, v20
    v_mul_f32 v88, v88, v20
    v_mul_f32 v89, v89, v20
    v_mul_f32 v90, v90, v20
    v_mul_f32 v91, v91, v20
    v_mul_f32 v92, v92, v20
    v_mul_f32 v93, v93, v20
    v_mul_f32 v94, v94, v20
    v_mul_f32 v95, v95, v20
    v_cvt_pk_bf16_f32 v52, v36, v37
    v_cvt_pk_bf16_f32 v53, v38, v39
    v_cvt_pk_bf16_f32 v54, v40, v41
    v_cvt_pk_bf16_f32 v55, v42, v43
    v_cvt_pk_bf16_f32 v56, v44, v45
    v_cvt_pk_bf16_f32 v57, v46, v47
    v_cvt_pk_bf16_f32 v58, v48, v49
    v_cvt_pk_bf16_f32 v59, v50, v51
    s_nop 1
    v_mfma_f32_16x16x32_bf16 v[64:67], a[160:163], v[52:55], v[64:67]
    v_mfma_f32_16x16x32_bf16 v[68:71], a[164:167], v[52:55], v[68:71]
    v_mfma_f32_16x16x32_bf16 v[72:75], a[168:171], v[52:55], v[72:75]
    v_mfma_f32_16x16x32_bf16 v[76:79], a[172:175], v[52:55], v[76:79]
    v_mfma_f32_16x16x32_bf16 v[80:83], a[176:179], v[52:55], v[80:83]
    v_mfma_f32_16x16x32_bf16 v[84:87], a[180:183], v[52:55], v[84:87]
    v_mfma_f32_16x16x32_bf16 v[88:91], a[184:187], v[52:55], v[88:91]
    v_mfma_f32_16x16x32_bf16 v[92:95], a[188:191], v[52:55], v[92:95]
    v_mfma_f32_16x16x32_bf16 v[64:67], a[192:195], v[56:59], v[64:67]
    v_mfma_f32_16x16x32_bf16 v[68:71], a[196:199], v[56:59], v[68:71]
    v_mfma_f32_16x16x32_bf16 v[72:75], a[200:203], v[56:59], v[72:75]
    v_mfma_f32_16x16x32_bf16 v[76:79], a[204:207], v[56:59], v[76:79]
    v_mfma_f32_16x16x32_bf16 v[80:83], a[208:211], v[56:59], v[80:83]
    v_mfma_f32_16x16x32_bf16 v[84:87], a[212:215], v[56:59], v[84:87]
    v_mfma_f32_16x16x32_bf16 v[88:91], a[216:219], v[56:59], v[88:91]
    v_mfma_f32_16x16x32_bf16 v[92:95], a[220:223], v[56:59], v[92:95]
    v_mfma_f32_16x16x32_bf16 v[36:39], a[96:99], a[16:19], 0
    v_mfma_f32_16x16x32_bf16 v[36:39], a[100:103], a[20:23], v[36:39]
    v_mfma_f32_16x16x32_bf16 v[36:39], a[104:107], a[24:27], v[36:39]
    v_mfma_f32_16x16x32_bf16 v[36:39], a[108:111], a[28:31], v[36:39]
    v_mfma_f32_16x16x32_bf16 v[40:43], a[112:115], a[16:19], 0
    v_mfma_f32_16x16x32_bf16 v[40:43], a[116:119], a[20:23], v[40:43]
    v_mfma_f32_16x16x32_bf16 v[40:43], a[120:123], a[24:27], v[40:43]
    v_mfma_f32_16x16x32_bf16 v[40:43], a[124:127], a[28:31], v[40:43]
    v_mfma_f32_16x16x32_bf16 v[44:47], a[128:131], a[16:19], 0
    v_mfma_f32_16x16x32_bf16 v[44:47], a[132:135], a[20:23], v[44:47]
    v_mfma_f32_16x16x32_bf16 v[44:47], a[136:139], a[24:27], v[44:47]
    v_mfma_f32_16x16x32_bf16 v[44:47], a[140:143], a[28:31], v[44:47]
    v_mfma_f32_16x16x32_bf16 v[48:51], a[144:147], a[16:19], 0
    v_mfma_f32_16x16x32_bf16 v[48:51], a[148:151], a[20:23], v[48:51]
    v_mfma_f32_16x16x32_bf16 v[48:51], a[152:155], a[24:27], v[48:51]
    v_mfma_f32_16x16x32_bf16 v[48:51], a[156:159], a[28:31], v[48:51]
    s_nop 7
    v_max3_f32 v10, v36, v37, v38
    v_max3_f32 v10, v10, v39, v40
    v_max3_f32 v10, v10, v41, v42
    v_max3_f32 v10, v10, v43, v44
    v_max3_f32 v10, v10, v45, v46
    v_max3_f32 v10, v10, v47, v48
    v_max3_f32 v10, v10, v49, v50
    v_max3_f32 v10, v10, v51, v13
    v_mov_b32 v11, v10
    s_nop 1
    v_permlane32_swap_b32 v11, v10
    v_max_f32 v10, v10, v11
    v_mov_b32 v11, v10
    s_nop 1
    v_permlane16_swap_b32 v11, v10
    v_max_f32 v10, v10, v11
    v_sub_f32 v20, v13, v10
    v_exp_f32 v20, v20
    v_mov_b32 v13, v10
    v_sub_f32 v36, v36, v10
    v_sub_f32 v37, v37, v10
    v_sub_f32 v38, v38, v10
    v_sub_f32 v39, v39, v10
    v_sub_f32 v40, v40, v10
    v_sub_f32 v41, v41, v10
    v_sub_f32 v42, v42, v10
    v_sub_f32 v43, v43, v10
    v_sub_f32 v44, v44, v10
    v_sub_f32 v45, v45, v10
    v_sub_f32 v46, v46, v10
    v_sub_f32 v47, v47, v10
    v_sub_f32 v48, v48, v10
    v_sub_f32 v49, v49, v10
    v_sub_f32 v50, v50, v10
    v_sub_f32 v51, v51, v10
    v_exp_f32 v36, v36
    v_exp_f32 v37, v37
    v_exp_f32 v38, v38
    v_exp_f32 v39, v39
    v_exp_f32 v40, v40
    v_exp_f32 v41, v41
    v_exp_f32 v42, v42
    v_exp_f32 v43, v43
    v_exp_f32 v44, v44
    v_exp_f32 v45, v45
    v_exp_f32 v46, v46
    v_exp_f32 v47, v47
    v_exp_f32 v48, v48
    v_exp_f32 v49, v49
    v_exp_f32 v50, v50
    v_exp_f32 v51, v51
    v_mul_f32 v5, v5, v20
    v_add_f32 v5, v5, v36
    v_add_f32 v5, v5, v37
    v_add_f32 v5, v5, v38
    v_add_f32 v5, v5, v39
    v_add_f32 v5, v5, v40
    v_add_f32 v5, v5, v41
    v_add_f32 v5, v5, v42
    v_add_f32 v5, v5, v43
    v_add_f32 v5, v5, v44
    v_add_f32 v5, v5, v45
    v_add_f32 v5, v5, v46
    v_add_f32 v5, v5, v47
    v_add_f32 v5, v5, v48
    v_add_f32 v5, v5, v49
    v_add_f32 v5, v5, v50
    v_add_f32 v5, v5, v51
    v_mul_f32 v96, v96, v20
    v_mul_f32 v97, v97, v20
    v_mul_f32 v98, v98, v20
    v_mul_f32 v99, v99, v20
    v_mul_f32 v100, v100, v20
    v_mul_f32 v101, v101, v20
    v_mul_f32 v102, v102, v20
    v_mul_f32 v103, v103, v20
    v_mul_f32 v104, v104, v20
    v_mul_f32 v105, v105, v20
    v_mul_f32 v106, v106, v20
    v_mul_f32 v107, v107, v20
    v_mul_f32 v108, v108, v20
    v_mul_f32 v109, v109, v20
    v_mul_f32 v110, v110, v20
    v_mul_f32 v111, v111, v20
    v_mul_f32 v112, v112, v20
    v_mul_f32 v113, v113, v20
    v_mul_f32 v114, v114, v20
    v_mul_f32 v115, v115, v20
    v_mul_f32 v116, v116, v20
    v_mul_f32 v117, v117, v20
    v_mul_f32 v118, v118, v20
    v_mul_f32 v119, v119, v20
    v_mul_f32 v120, v120, v20
    v_mul_f32 v121, v121, v20
    v_mul_f32 v122, v122, v20
    v_mul_f32 v123, v123, v20
    v_mul_f32 v124, v124, v20
    v_mul_f32 v125, v125, v20
    v_mul_f32 v126, v126, v20
    v_mul_f32 v127, v127, v20
    v_cvt_pk_bf16_f32 v52, v36, v37
    v_cvt_pk_bf16_f32 v53, v38, v39
    v_cvt_pk_bf16_f32 v54, v40, v41
    v_cvt_pk_bf16_f32 v55, v42, v43
    v_cvt_pk_bf16_f32 v56, v44, v45
    v_cvt_pk_bf16_f32 v57, v46, v47
    v_cvt_pk_bf16_f32 v58, v48, v49
    v_cvt_pk_bf16_f32 v59, v50, v51
    s_nop 1
    v_mfma_f32_16x16x32_bf16 v[96:99], a[160:163], v[52:55], v[96:99]
    v_mfma_f32_16x16x32_bf16 v[100:103], a[164:167], v[52:55], v[100:103]
    v_mfma_f32_16x16x32_bf16 v[104:107], a[168:171], v[52:55], v[104:107]
    v_mfma_f32_16x16x32_bf16 v[108:111], a[172:175], v[52:55], v[108:111]
    v_mfma_f32_16x16x32_bf16 v[112:115], a[176:179], v[52:55], v[112:115]
    v_mfma_f32_16x16x32_bf16 v[116:119], a[180:183], v[52:55], v[116:119]
    v_mfma_f32_16x16x32_bf16 v[120:123], a[184:187], v[52:55], v[120:123]
    v_mfma_f32_16x16x32_bf16 v[124:127], a[188:191], v[52:55], v[124:127]
    v_mfma_f32_16x16x32_bf16 v[96:99], a[192:195], v[56:59], v[96:99]
    v_mfma_f32_16x16x32_bf16 v[100:103], a[196:199], v[56:59], v[100:103]
    v_mfma_f32_16x16x32_bf16 v[104:107], a[200:203], v[56:59], v[104:107]
    v_mfma_f32_16x16x32_bf16 v[108:111], a[204:207], v[56:59], v[108:111]
    v_mfma_f32_16x16x32_bf16 v[112:115], a[208:211], v[56:59], v[112:115]
    v_mfma_f32_16x16x32_bf16 v[116:119], a[212:215], v[56:59], v[116:119]
    v_mfma_f32_16x16x32_bf16 v[120:123], a[216:219], v[56:59], v[120:123]
    v_mfma_f32_16x16x32_bf16 v[124:127], a[220:223], v[56:59], v[124:127]
    v_mfma_f32_16x16x32_bf16 v[36:39], a[96:99], a[32:35], 0
    v_mfma_f32_16x16x32_bf16 v[36:39], a[100:103], a[36:39], v[36:39]
    v_mfma_f32_16x16x32_bf16 v[36:39], a[104:107], a[40:43], v[36:39]
    v_mfma_f32_16x16x32_bf16 v[36:39], a[108:111], a[44:47], v[36:39]
    v_mfma_f32_16x16x32_bf16 v[40:43], a[112:115], a[32:35], 0
    v_mfma_f32_16x16x32_bf16 v[40:43], a[116:119], a[36:39], v[40:43]
    v_mfma_f32_16x16x32_bf16 v[40:43], a[120:123], a[40:43], v[40:43]
    v_mfma_f32_16x16x32_bf16 v[40:43], a[124:127], a[44:47], v[40:43]
    v_mfma_f32_16x16x32_bf16 v[44:47], a[128:131], a[32:35], 0
    v_mfma_f32_16x16x32_bf16 v[44:47], a[132:135], a[36:39], v[44:47]
    v_mfma_f32_16x16x32_bf16 v[44:47], a[136:139], a[40:43], v[44:47]
    v_mfma_f32_16x16x32_bf16 v[44:47], a[140:143], a[44:47], v[44:47]
    v_mfma_f32_16x16x32_bf16 v[48:51], a[144:147], a[32:35], 0
    v_mfma_f32_16x16x32_bf16 v[48:51], a[148:151], a[36:39], v[48:51]
    v_mfma_f32_16x16x32_bf16 v[48:51], a[152:155], a[40:43], v[48:51]
    v_mfma_f32_16x16x32_bf16 v[48:51], a[156:159], a[44:47], v[48:51]
    s_nop 7
    v_max3_f32 v10, v36, v37, v38
    v_max3_f32 v10, v10, v39, v40
    v_max3_f32 v10, v10, v41, v42
    v_max3_f32 v10, v10, v43, v44
    v_max3_f32 v10, v10, v45, v46
    v_max3_f32 v10, v10, v47, v48
    v_max3_f32 v10, v10, v49, v50
    v_max3_f32 v10, v10, v51, v14
    v_mov_b32 v11, v10
    s_nop 1
    v_permlane32_swap_b32 v11, v10
    v_max_f32 v10, v10, v11
    v_mov_b32 v11, v10
    s_nop 1
    v_permlane16_swap_b32 v11, v10
    v_max_f32 v10, v10, v11
    v_sub_f32 v20, v14, v10
    v_exp_f32 v20, v20
    v_mov_b32 v14, v10
    v_sub_f32 v36, v36, v10
    v_sub_f32 v37, v37, v10
    v_sub_f32 v38, v38, v10
    v_sub_f32 v39, v39, v10
    v_sub_f32 v40, v40, v10
    v_sub_f32 v41, v41, v10
    v_sub_f32 v42, v42, v10
    v_sub_f32 v43, v43, v10
    v_sub_f32 v44, v44, v10
    v_sub_f32 v45, v45, v10
    v_sub_f32 v46, v46, v10
    v_sub_f32 v47, v47, v10
    v_sub_f32 v48, v48, v10
    v_sub_f32 v49, v49, v10
    v_sub_f32 v50, v50, v10
    v_sub_f32 v51, v51, v10
    v_exp_f32 v36, v36
    v_exp_f32 v37, v37
    v_exp_f32 v38, v38
    v_exp_f32 v39, v39
    v_exp_f32 v40, v40
    v_exp_f32 v41, v41
    v_exp_f32 v42, v42
    v_exp_f32 v43, v43
    v_exp_f32 v44, v44
    v_exp_f32 v45, v45
    v_exp_f32 v46, v46
    v_exp_f32 v47, v47
    v_exp_f32 v48, v48
    v_exp_f32 v49, v49
    v_exp_f32 v50, v50
    v_exp_f32 v51, v51
    v_mul_f32 v6, v6, v20
    v_add_f32 v6, v6, v36
    v_add_f32 v6, v6, v37
    v_add_f32 v6, v6, v38
    v_add_f32 v6, v6, v39
    v_add_f32 v6, v6, v40
    v_add_f32 v6, v6, v41
    v_add_f32 v6, v6, v42
    v_add_f32 v6, v6, v43
    v_add_f32 v6, v6, v44
    v_add_f32 v6, v6, v45
    v_add_f32 v6, v6, v46
    v_add_f32 v6, v6, v47
    v_add_f32 v6, v6, v48
    v_add_f32 v6, v6, v49
    v_add_f32 v6, v6, v50
    v_add_f32 v6, v6, v51
    v_mul_f32 v128, v128, v20
    v_mul_f32 v129, v129, v20
    v_mul_f32 v130, v130, v20
    v_mul_f32 v131, v131, v20
    v_mul_f32 v132, v132, v20
    v_mul_f32 v133, v133, v20
    v_mul_f32 v134, v134, v20
    v_mul_f32 v135, v135, v20
    v_mul_f32 v136, v136, v20
    v_mul_f32 v137, v137, v20
    v_mul_f32 v138, v138, v20
    v_mul_f32 v139, v139, v20
    v_mul_f32 v140, v140, v20
    v_mul_f32 v141, v141, v20
    v_mul_f32 v142, v142, v20
    v_mul_f32 v143, v143, v20
    v_mul_f32 v144, v144, v20
    v_mul_f32 v145, v145, v20
    v_mul_f32 v146, v146, v20
    v_mul_f32 v147, v147, v20
    v_mul_f32 v148, v148, v20
    v_mul_f32 v149, v149, v20
    v_mul_f32 v150, v150, v20
    v_mul_f32 v151, v151, v20
    v_mul_f32 v152, v152, v20
    v_mul_f32 v153, v153, v20
    v_mul_f32 v154, v154, v20
    v_mul_f32 v155, v155, v20
    v_mul_f32 v156, v156, v20
    v_mul_f32 v157, v157, v20
    v_mul_f32 v158, v158, v20
    v_mul_f32 v159, v159, v20
    v_cvt_pk_bf16_f32 v52, v36, v37
    v_cvt_pk_bf16_f32 v53, v38, v39
    v_cvt_pk_bf16_f32 v54, v40, v41
    v_cvt_pk_bf16_f32 v55, v42, v43
    v_cvt_pk_bf16_f32 v56, v44, v45
    v_cvt_pk_bf16_f32 v57, v46, v47
    v_cvt_pk_bf16_f32 v58, v48, v49
    v_cvt_pk_bf16_f32 v59, v50, v51
    s_nop 1
    v_mfma_f32_16x16x32_bf16 v[128:131], a[160:163], v[52:55], v[128:131]
    v_mfma_f32_16x16x32_bf16 v[132:135], a[164:167], v[52:55], v[132:135]
    v_mfma_f32_16x16x32_bf16 v[136:139], a[168:171], v[52:55], v[136:139]
    v_mfma_f32_16x16x32_bf16 v[140:143], a[172:175], v[52:55], v[140:143]
    v_mfma_f32_16x16x32_bf16 v[144:147], a[176:179], v[52:55], v[144:147]
    v_mfma_f32_16x16x32_bf16 v[148:151], a[180:183], v[52:55], v[148:151]
    v_mfma_f32_16x16x32_bf16 v[152:155], a[184:187], v[52:55], v[152:155]
    v_mfma_f32_16x16x32_bf16 v[156:159], a[188:191], v[52:55], v[156:159]
    v_mfma_f32_16x16x32_bf16 v[128:131], a[192:195], v[56:59], v[128:131]
    v_mfma_f32_16x16x32_bf16 v[132:135], a[196:199], v[56:59], v[132:135]
    v_mfma_f32_16x16x32_bf16 v[136:139], a[200:203], v[56:59], v[136:139]
    v_mfma_f32_16x16x32_bf16 v[140:143], a[204:207], v[56:59], v[140:143]
    v_mfma_f32_16x16x32_bf16 v[144:147], a[208:211], v[56:59], v[144:147]
    v_mfma_f32_16x16x32_bf16 v[148:151], a[212:215], v[56:59], v[148:151]
    v_mfma_f32_16x16x32_bf16 v[152:155], a[216:219], v[56:59], v[152:155]
    v_mfma_f32_16x16x32_bf16 v[156:159], a[220:223], v[56:59], v[156:159]
    v_mfma_f32_16x16x32_bf16 v[36:39], a[96:99], a[48:51], 0
    v_mfma_f32_16x16x32_bf16 v[36:39], a[100:103], a[52:55], v[36:39]
    v_mfma_f32_16x16x32_bf16 v[36:39], a[104:107], a[56:59], v[36:39]
    v_mfma_f32_16x16x32_bf16 v[36:39], a[108:111], a[60:63], v[36:39]
    v_mfma_f32_16x16x32_bf16 v[40:43], a[112:115], a[48:51], 0
    v_mfma_f32_16x16x32_bf16 v[40:43], a[116:119], a[52:55], v[40:43]
    v_mfma_f32_16x16x32_bf16 v[40:43], a[120:123], a[56:59], v[40:43]
    v_mfma_f32_16x16x32_bf16 v[40:43], a[124:127], a[60:63], v[40:43]
    v_mfma_f32_16x16x32_bf16 v[44:47], a[128:131], a[48:51], 0
    v_mfma_f32_16x16x32_bf16 v[44:47], a[132:135], a[52:55], v[44:47]
    v_mfma_f32_16x16x32_bf16 v[44:47], a[136:139], a[56:59], v[44:47]
    v_mfma_f32_16x16x32_bf16 v[44:47], a[140:143], a[60:63], v[44:47]
    v_mfma_f32_16x16x32_bf16 v[48:51], a[144:147], a[48:51], 0
    v_mfma_f32_16x16x32_bf16 v[48:51], a[148:151], a[52:55], v[48:51]
    v_mfma_f32_16x16x32_bf16 v[48:51], a[152:155], a[56:59], v[48:51]
    v_mfma_f32_16x16x32_bf16 v[48:51], a[156:159], a[60:63], v[48:51]
    s_nop 7
    v_max3_f32 v10, v36, v37, v38
    v_max3_f32 v10, v10, v39, v40
    v_max3_f32 v10, v10, v41, v42
    v_max3_f32 v10, v10, v43, v44
    v_max3_f32 v10, v10, v45, v46
    v_max3_f32 v10, v10, v47, v48
    v_max3_f32 v10, v10, v49, v50
    v_max3_f32 v10, v10, v51, v15
    v_mov_b32 v11, v10
    s_nop 1
    v_permlane32_swap_b32 v11, v10
    v_max_f32 v10, v10, v11
    v_mov_b32 v11, v10
    s_nop 1
    v_permlane16_swap_b32 v11, v10
    v_max_f32 v10, v10, v11
    v_sub_f32 v20, v15, v10
    v_exp_f32 v20, v20
    v_mov_b32 v15, v10
    v_sub_f32 v36, v36, v10
    v_sub_f32 v37, v37, v10
    v_sub_f32 v38, v38, v10
    v_sub_f32 v39, v39, v10
    v_sub_f32 v40, v40, v10
    v_sub_f32 v41, v41, v10
    v_sub_f32 v42, v42, v10
    v_sub_f32 v43, v43, v10
    v_sub_f32 v44, v44, v10
    v_sub_f32 v45, v45, v10
    v_sub_f32 v46, v46, v10
    v_sub_f32 v47, v47, v10
    v_sub_f32 v48, v48, v10
    v_sub_f32 v49, v49, v10
    v_sub_f32 v50, v50, v10
    v_sub_f32 v51, v51, v10
    v_exp_f32 v36, v36
    v_exp_f32 v37, v37
    v_exp_f32 v38, v38
    v_exp_f32 v39, v39
    v_exp_f32 v40, v40
    v_exp_f32 v41, v41
    v_exp_f32 v42, v42
    v_exp_f32 v43, v43
    v_exp_f32 v44, v44
    v_exp_f32 v45, v45
    v_exp_f32 v46, v46
    v_exp_f32 v47, v47
    v_exp_f32 v48, v48
    v_exp_f32 v49, v49
    v_exp_f32 v50, v50
    v_exp_f32 v51, v51
    v_mul_f32 v7, v7, v20
    v_add_f32 v7, v7, v36
    v_add_f32 v7, v7, v37
    v_add_f32 v7, v7, v38
    v_add_f32 v7, v7, v39
    v_add_f32 v7, v7, v40
    v_add_f32 v7, v7, v41
    v_add_f32 v7, v7, v42
    v_add_f32 v7, v7, v43
    v_add_f32 v7, v7, v44
    v_add_f32 v7, v7, v45
    v_add_f32 v7, v7, v46
    v_add_f32 v7, v7, v47
    v_add_f32 v7, v7, v48
    v_add_f32 v7, v7, v49
    v_add_f32 v7, v7, v50
    v_add_f32 v7, v7, v51
    v_mul_f32 v160, v160, v20
    v_mul_f32 v161, v161, v20
    v_mul_f32 v162, v162, v20
    v_mul_f32 v163, v163, v20
    v_mul_f32 v164, v164, v20
    v_mul_f32 v165, v165, v20
    v_mul_f32 v166, v166, v20
    v_mul_f32 v167, v167, v20
    v_mul_f32 v168, v168, v20
    v_mul_f32 v169, v169, v20
    v_mul_f32 v170, v170, v20
    v_mul_f32 v171, v171, v20
    v_mul_f32 v172, v172, v20
    v_mul_f32 v173, v173, v20
    v_mul_f32 v174, v174, v20
    v_mul_f32 v175, v175, v20
    v_mul_f32 v176, v176, v20
    v_mul_f32 v177, v177, v20
    v_mul_f32 v178, v178, v20
    v_mul_f32 v179, v179, v20
    v_mul_f32 v180, v180, v20
    v_mul_f32 v181, v181, v20
    v_mul_f32 v182, v182, v20
    v_mul_f32 v183, v183, v20
    v_mul_f32 v184, v184, v20
    v_mul_f32 v185, v185, v20
    v_mul_f32 v186, v186, v20
    v_mul_f32 v187, v187, v20
    v_mul_f32 v188, v188, v20
    v_mul_f32 v189, v189, v20
    v_mul_f32 v190, v190, v20
    v_mul_f32 v191, v191, v20
    v_cvt_pk_bf16_f32 v52, v36, v37
    v_cvt_pk_bf16_f32 v53, v38, v39
    v_cvt_pk_bf16_f32 v54, v40, v41
    v_cvt_pk_bf16_f32 v55, v42, v43
    v_cvt_pk_bf16_f32 v56, v44, v45
    v_cvt_pk_bf16_f32 v57, v46, v47
    v_cvt_pk_bf16_f32 v58, v48, v49
    v_cvt_pk_bf16_f32 v59, v50, v51
    s_nop 1
    v_mfma_f32_16x16x32_bf16 v[160:163], a[160:163], v[52:55], v[160:163]
    v_mfma_f32_16x16x32_bf16 v[164:167], a[164:167], v[52:55], v[164:167]
    v_mfma_f32_16x16x32_bf16 v[168:171], a[168:171], v[52:55], v[168:171]
    v_mfma_f32_16x16x32_bf16 v[172:175], a[172:175], v[52:55], v[172:175]
    v_mfma_f32_16x16x32_bf16 v[176:179], a[176:179], v[52:55], v[176:179]
    v_mfma_f32_16x16x32_bf16 v[180:183], a[180:183], v[52:55], v[180:183]
    v_mfma_f32_16x16x32_bf16 v[184:187], a[184:187], v[52:55], v[184:187]
    v_mfma_f32_16x16x32_bf16 v[188:191], a[188:191], v[52:55], v[188:191]
    v_mfma_f32_16x16x32_bf16 v[160:163], a[192:195], v[56:59], v[160:163]
    v_mfma_f32_16x16x32_bf16 v[164:167], a[196:199], v[56:59], v[164:167]
    v_mfma_f32_16x16x32_bf16 v[168:171], a[200:203], v[56:59], v[168:171]
    v_mfma_f32_16x16x32_bf16 v[172:175], a[204:207], v[56:59], v[172:175]
    v_mfma_f32_16x16x32_bf16 v[176:179], a[208:211], v[56:59], v[176:179]
    v_mfma_f32_16x16x32_bf16 v[180:183], a[212:215], v[56:59], v[180:183]
    v_mfma_f32_16x16x32_bf16 v[184:187], a[216:219], v[56:59], v[184:187]
    v_mfma_f32_16x16x32_bf16 v[188:191], a[220:223], v[56:59], v[188:191]
    v_mfma_f32_16x16x32_bf16 v[36:39], a[96:99], a[64:67], 0
    v_mfma_f32_16x16x32_bf16 v[36:39], a[100:103], a[68:71], v[36:39]
    v_mfma_f32_16x16x32_bf16 v[36:39], a[104:107], a[72:75], v[36:39]
    v_mfma_f32_16x16x32_bf16 v[36:39], a[108:111], a[76:79], v[36:39]
    v_mfma_f32_16x16x32_bf16 v[40:43], a[112:115], a[64:67], 0
    v_mfma_f32_16x16x32_bf16 v[40:43], a[116:119], a[68:71], v[40:43]
    v_mfma_f32_16x16x32_bf16 v[40:43], a[120:123], a[72:75], v[40:43]
    v_mfma_f32_16x16x32_bf16 v[40:43], a[124:127], a[76:79], v[40:43]
    v_mfma_f32_16x16x32_bf16 v[44:47], a[128:131], a[64:67], 0
    v_mfma_f32_16x16x32_bf16 v[44:47], a[132:135], a[68:71], v[44:47]
    v_mfma_f32_16x16x32_bf16 v[44:47], a[136:139], a[72:75], v[44:47]
    v_mfma_f32_16x16x32_bf16 v[44:47], a[140:143], a[76:79], v[44:47]
    v_mfma_f32_16x16x32_bf16 v[48:51], a[144:147], a[64:67], 0
    v_mfma_f32_16x16x32_bf16 v[48:51], a[148:151], a[68:71], v[48:51]
    v_mfma_f32_16x16x32_bf16 v[48:51], a[152:155], a[72:75], v[48:51]
    v_mfma_f32_16x16x32_bf16 v[48:51], a[156:159], a[76:79], v[48:51]
    s_nop 7
    v_max3_f32 v10, v36, v37, v38
    v_max3_f32 v10, v10, v39, v40
    v_max3_f32 v10, v10, v41, v42
    v_max3_f32 v10, v10, v43, v44
    v_max3_f32 v10, v10, v45, v46
    v_max3_f32 v10, v10, v47, v48
    v_max3_f32 v10, v10, v49, v50
    v_max3_f32 v10, v10, v51, v16
    v_mov_b32 v11, v10
    s_nop 1
    v_permlane32_swap_b32 v11, v10
    v_max_f32 v10, v10, v11
    v_mov_b32 v11, v10
    s_nop 1
    v_permlane16_swap_b32 v11, v10
    v_max_f32 v10, v10, v11
    v_sub_f32 v20, v16, v10
    v_exp_f32 v20, v20
    v_mov_b32 v16, v10
    v_sub_f32 v36, v36, v10
    v_sub_f32 v37, v37, v10
    v_sub_f32 v38, v38, v10
    v_sub_f32 v39, v39, v10
    v_sub_f32 v40, v40, v10
    v_sub_f32 v41, v41, v10
    v_sub_f32 v42, v42, v10
    v_sub_f32 v43, v43, v10
    v_sub_f32 v44, v44, v10
    v_sub_f32 v45, v45, v10
    v_sub_f32 v46, v46, v10
    v_sub_f32 v47, v47, v10
    v_sub_f32 v48, v48, v10
    v_sub_f32 v49, v49, v10
    v_sub_f32 v50, v50, v10
    v_sub_f32 v51, v51, v10
    v_exp_f32 v36, v36
    v_exp_f32 v37, v37
    v_exp_f32 v38, v38
    v_exp_f32 v39, v39
    v_exp_f32 v40, v40
    v_exp_f32 v41, v41
    v_exp_f32 v42, v42
    v_exp_f32 v43, v43
    v_exp_f32 v44, v44
    v_exp_f32 v45, v45
    v_exp_f32 v46, v46
    v_exp_f32 v47, v47
    v_exp_f32 v48, v48
    v_exp_f32 v49, v49
    v_exp_f32 v50, v50
    v_exp_f32 v51, v51
    v_mul_f32 v8, v8, v20
    v_add_f32 v8, v8, v36
    v_add_f32 v8, v8, v37
    v_add_f32 v8, v8, v38
    v_add_f32 v8, v8, v39
    v_add_f32 v8, v8, v40
    v_add_f32 v8, v8, v41
    v_add_f32 v8, v8, v42
    v_add_f32 v8, v8, v43
    v_add_f32 v8, v8, v44
    v_add_f32 v8, v8, v45
    v_add_f32 v8, v8, v46
    v_add_f32 v8, v8, v47
    v_add_f32 v8, v8, v48
    v_add_f32 v8, v8, v49
    v_add_f32 v8, v8, v50
    v_add_f32 v8, v8, v51
    v_mul_f32 v192, v192, v20
    v_mul_f32 v193, v193, v20
    v_mul_f32 v194, v194, v20
    v_mul_f32 v195, v195, v20
    v_mul_f32 v196, v196, v20
    v_mul_f32 v197, v197, v20
    v_mul_f32 v198, v198, v20
    v_mul_f32 v199, v199, v20
    v_mul_f32 v200, v200, v20
    v_mul_f32 v201, v201, v20
    v_mul_f32 v202, v202, v20
    v_mul_f32 v203, v203, v20
    v_mul_f32 v204, v204, v20
    v_mul_f32 v205, v205, v20
    v_mul_f32 v206, v206, v20
    v_mul_f32 v207, v207, v20
    v_mul_f32 v208, v208, v20
    v_mul_f32 v209, v209, v20
    v_mul_f32 v210, v210, v20
    v_mul_f32 v211, v211, v20
    v_mul_f32 v212, v212, v20
    v_mul_f32 v213, v213, v20
    v_mul_f32 v214, v214, v20
    v_mul_f32 v215, v215, v20
    v_mul_f32 v216, v216, v20
    v_mul_f32 v217, v217, v20
    v_mul_f32 v218, v218, v20
    v_mul_f32 v219, v219, v20
    v_mul_f32 v220, v220, v20
    v_mul_f32 v221, v221, v20
    v_mul_f32 v222, v222, v20
    v_mul_f32 v223, v223, v20
    v_cvt_pk_bf16_f32 v52, v36, v37
    v_cvt_pk_bf16_f32 v53, v38, v39
    v_cvt_pk_bf16_f32 v54, v40, v41
    v_cvt_pk_bf16_f32 v55, v42, v43
    v_cvt_pk_bf16_f32 v56, v44, v45
    v_cvt_pk_bf16_f32 v57, v46, v47
    v_cvt_pk_bf16_f32 v58, v48, v49
    v_cvt_pk_bf16_f32 v59, v50, v51
    s_nop 1
    v_mfma_f32_16x16x32_bf16 v[192:195], a[160:163], v[52:55], v[192:195]
    v_mfma_f32_16x16x32_bf16 v[196:199], a[164:167], v[52:55], v[196:199]
    v_mfma_f32_16x16x32_bf16 v[200:203], a[168:171], v[52:55], v[200:203]
    v_mfma_f32_16x16x32_bf16 v[204:207], a[172:175], v[52:55], v[204:207]
    v_mfma_f32_16x16x32_bf16 v[208:211], a[176:179], v[52:55], v[208:211]
    v_mfma_f32_16x16x32_bf16 v[212:215], a[180:183], v[52:55], v[212:215]
    v_mfma_f32_16x16x32_bf16 v[216:219], a[184:187], v[52:55], v[216:219]
    v_mfma_f32_16x16x32_bf16 v[220:223], a[188:191], v[52:55], v[220:223]
    v_mfma_f32_16x16x32_bf16 v[192:195], a[192:195], v[56:59], v[192:195]
    v_mfma_f32_16x16x32_bf16 v[196:199], a[196:199], v[56:59], v[196:199]
    v_mfma_f32_16x16x32_bf16 v[200:203], a[200:203], v[56:59], v[200:203]
    v_mfma_f32_16x16x32_bf16 v[204:207], a[204:207], v[56:59], v[204:207]
    v_mfma_f32_16x16x32_bf16 v[208:211], a[208:211], v[56:59], v[208:211]
    v_mfma_f32_16x16x32_bf16 v[212:215], a[212:215], v[56:59], v[212:215]
    v_mfma_f32_16x16x32_bf16 v[216:219], a[216:219], v[56:59], v[216:219]
    v_mfma_f32_16x16x32_bf16 v[220:223], a[220:223], v[56:59], v[220:223]
    v_mfma_f32_16x16x32_bf16 v[36:39], a[96:99], a[80:83], 0
    v_mfma_f32_16x16x32_bf16 v[36:39], a[100:103], a[84:87], v[36:39]
    v_mfma_f32_16x16x32_bf16 v[36:39], a[104:107], a[88:91], v[36:39]
    v_mfma_f32_16x16x32_bf16 v[36:39], a[108:111], a[92:95], v[36:39]
    v_mfma_f32_16x16x32_bf16 v[40:43], a[112:115], a[80:83], 0
    v_mfma_f32_16x16x32_bf16 v[40:43], a[116:119], a[84:87], v[40:43]
    v_mfma_f32_16x16x32_bf16 v[40:43], a[120:123], a[88:91], v[40:43]
    v_mfma_f32_16x16x32_bf16 v[40:43], a[124:127], a[92:95], v[40:43]
    v_mfma_f32_16x16x32_bf16 v[44:47], a[128:131], a[80:83], 0
    v_mfma_f32_16x16x32_bf16 v[44:47], a[132:135], a[84:87], v[44:47]
    v_mfma_f32_16x16x32_bf16 v[44:47], a[136:139], a[88:91], v[44:47]
    v_mfma_f32_16x16x32_bf16 v[44:47], a[140:143], a[92:95], v[44:47]
    v_mfma_f32_16x16x32_bf16 v[48:51], a[144:147], a[80:83], 0
    v_mfma_f32_16x16x32_bf16 v[48:51], a[148:151], a[84:87], v[48:51]
    v_mfma_f32_16x16x32_bf16 v[48:51], a[152:155], a[88:91], v[48:51]
    v_mfma_f32_16x16x32_bf16 v[48:51], a[156:159], a[92:95], v[48:51]
    s_nop 7
    v_max3_f32 v10, v36, v37, v38
    v_max3_f32 v10, v10, v39, v40
    v_max3_f32 v10, v10, v41, v42
    v_max3_f32 v10, v10, v43, v44
    v_max3_f32 v10, v10, v45, v46
    v_max3_f32 v10, v10, v47, v48
    v_max3_f32 v10, v10, v49, v50
    v_max3_f32 v10, v10, v51, v17
    v_mov_b32 v11, v10
    s_nop 1
    v_permlane32_swap_b32 v11, v10
    v_max_f32 v10, v10, v11
    v_mov_b32 v11, v10
    s_nop 1
    v_permlane16_swap_b32 v11, v10
    v_max_f32 v10, v10, v11
    v_sub_f32 v20, v17, v10
    v_exp_f32 v20, v20
    v_mov_b32 v17, v10
    v_sub_f32 v36, v36, v10
    v_sub_f32 v37, v37, v10
    v_sub_f32 v38, v38, v10
    v_sub_f32 v39, v39, v10
    v_sub_f32 v40, v40, v10
    v_sub_f32 v41, v41, v10
    v_sub_f32 v42, v42, v10
    v_sub_f32 v43, v43, v10
    v_sub_f32 v44, v44, v10
    v_sub_f32 v45, v45, v10
    v_sub_f32 v46, v46, v10
    v_sub_f32 v47, v47, v10
    v_sub_f32 v48, v48, v10
    v_sub_f32 v49, v49, v10
    v_sub_f32 v50, v50, v10
    v_sub_f32 v51, v51, v10
    v_exp_f32 v36, v36
    v_exp_f32 v37, v37
    v_exp_f32 v38, v38
    v_exp_f32 v39, v39
    v_exp_f32 v40, v40
    v_exp_f32 v41, v41
    v_exp_f32 v42, v42
    v_exp_f32 v43, v43
    v_exp_f32 v44, v44
    v_exp_f32 v45, v45
    v_exp_f32 v46, v46
    v_exp_f32 v47, v47
    v_exp_f32 v48, v48
    v_exp_f32 v49, v49
    v_exp_f32 v50, v50
    v_exp_f32 v51, v51
    v_mul_f32 v9, v9, v20
    v_add_f32 v9, v9, v36
    v_add_f32 v9, v9, v37
    v_add_f32 v9, v9, v38
    v_add_f32 v9, v9, v39
    v_add_f32 v9, v9, v40
    v_add_f32 v9, v9, v41
    v_add_f32 v9, v9, v42
    v_add_f32 v9, v9, v43
    v_add_f32 v9, v9, v44
    v_add_f32 v9, v9, v45
    v_add_f32 v9, v9, v46
    v_add_f32 v9, v9, v47
    v_add_f32 v9, v9, v48
    v_add_f32 v9, v9, v49
    v_add_f32 v9, v9, v50
    v_add_f32 v9, v9, v51
    v_mul_f32 v224, v224, v20
    v_mul_f32 v225, v225, v20
    v_mul_f32 v226, v226, v20
    v_mul_f32 v227, v227, v20
    v_mul_f32 v228, v228, v20
    v_mul_f32 v229, v229, v20
    v_mul_f32 v230, v230, v20
    v_mul_f32 v231, v231, v20
    v_mul_f32 v232, v232, v20
    v_mul_f32 v233, v233, v20
    v_mul_f32 v234, v234, v20
    v_mul_f32 v235, v235, v20
    v_mul_f32 v236, v236, v20
    v_mul_f32 v237, v237, v20
    v_mul_f32 v238, v238, v20
    v_mul_f32 v239, v239, v20
    v_mul_f32 v240, v240, v20
    v_mul_f32 v241, v241, v20
    v_mul_f32 v242, v242, v20
    v_mul_f32 v243, v243, v20
    v_mul_f32 v244, v244, v20
    v_mul_f32 v245, v245, v20
    v_mul_f32 v246, v246, v20
    v_mul_f32 v247, v247, v20
    v_mul_f32 v248, v248, v20
    v_mul_f32 v249, v249, v20
    v_mul_f32 v250, v250, v20
    v_mul_f32 v251, v251, v20
    v_mul_f32 v252, v252, v20
    v_mul_f32 v253, v253, v20
    v_mul_f32 v254, v254, v20
    v_mul_f32 v255, v255, v20
    v_cvt_pk_bf16_f32 v52, v36, v37
    v_cvt_pk_bf16_f32 v53, v38, v39
    v_cvt_pk_bf16_f32 v54, v40, v41
    v_cvt_pk_bf16_f32 v55, v42, v43
    v_cvt_pk_bf16_f32 v56, v44, v45
    v_cvt_pk_bf16_f32 v57, v46, v47
    v_cvt_pk_bf16_f32 v58, v48, v49
    v_cvt_pk_bf16_f32 v59, v50, v51
    s_nop 1
    v_mfma_f32_16x16x32_bf16 v[224:227], a[160:163], v[52:55], v[224:227]
    v_mfma_f32_16x16x32_bf16 v[228:231], a[164:167], v[52:55], v[228:231]
    v_mfma_f32_16x16x32_bf16 v[232:235], a[168:171], v[52:55], v[232:235]
    v_mfma_f32_16x16x32_bf16 v[236:239], a[172:175], v[52:55], v[236:239]
    v_mfma_f32_16x16x32_bf16 v[240:243], a[176:179], v[52:55], v[240:243]
    v_mfma_f32_16x16x32_bf16 v[244:247], a[180:183], v[52:55], v[244:247]
    v_mfma_f32_16x16x32_bf16 v[248:251], a[184:187], v[52:55], v[248:251]
    v_mfma_f32_16x16x32_bf16 v[252:255], a[188:191], v[52:55], v[252:255]
    v_mfma_f32_16x16x32_bf16 v[224:227], a[192:195], v[56:59], v[224:227]
    v_mfma_f32_16x16x32_bf16 v[228:231], a[196:199], v[56:59], v[228:231]
    v_mfma_f32_16x16x32_bf16 v[232:235], a[200:203], v[56:59], v[232:235]
    v_mfma_f32_16x16x32_bf16 v[236:239], a[204:207], v[56:59], v[236:239]
    v_mfma_f32_16x16x32_bf16 v[240:243], a[208:211], v[56:59], v[240:243]
    v_mfma_f32_16x16x32_bf16 v[244:247], a[212:215], v[56:59], v[244:247]
    v_mfma_f32_16x16x32_bf16 v[248:251], a[216:219], v[56:59], v[248:251]
    v_mfma_f32_16x16x32_bf16 v[252:255], a[220:223], v[56:59], v[252:255]
    s_add_u32 s22, s22, 1
    s_cmp_lt_u32 s22, 8
    s_cbranch_scc1 L_slow_tile
    s_mul_i32 s30, s20, 13056
    s_add_u32 s30, s30, 33280
    v_bfe_u32 v10, v0, 4, 2
    v_and_b32 v11, 15, v0
    v_mul_u32_u24 v60, 272, v11
    v_lshl_add_u32 v60, v10, 4, v60
    v_add_u32 v60, s30, v60
    v_mul_u32_u24 v61, 272, v10
    v_lshl_add_u32 v61, v11, 4, v61
    v_add_u32 v61, s30, v61
    s_mul_i32 s30, s20, 24576
    v_and_b32 v62, 63, v0
    v_lshlrev_b32 v62, 4, v62
    v_add_u32 v62, s30, v62
    v_lshlrev_b32 v63, 8, v11
    v_lshl_add_u32 v63, v10, 4, v63
    v_add_u32 v63, s30, v63
    v_mov_b32 v10, v4
    s_nop 1
    v_permlane32_swap_b32 v10, v4
    s_nop 1
    v_add_f32 v4, v4, v10
    v_mov_b32 v10, v4
    s_nop 1
    v_permlane16_swap_b32 v10, v4
    s_nop 1
    v_add_f32 v4, v4, v10
    v_cmp_nge_f32 vcc, s47, v4
    v_rcp_f32 v4, v4
    s_nop 7
    v_mul_f32 v64, v64, v4
    v_mul_f32 v65, v65, v4
    v_mul_f32 v66, v66, v4
    v_mul_f32 v67, v67, v4
    v_mul_f32 v68, v68, v4
    v_mul_f32 v69, v69, v4
    v_mul_f32 v70, v70, v4
    v_mul_f32 v71, v71, v4
    v_cvt_pk_bf16_f32 v64, v64, v65
    v_cvt_pk_bf16_f32 v65, v66, v67
    v_cvt_pk_bf16_f32 v66, v68, v69
    v_cvt_pk_bf16_f32 v67, v70, v71
    ds_write_b128 v60, v[64:67] offset:0
    v_mul_f32 v72, v72, v4
    v_mul_f32 v73, v73, v4
    v_mul_f32 v74, v74, v4
    v_mul_f32 v75, v75, v4
    v_mul_f32 v76, v76, v4
    v_mul_f32 v77, v77, v4
    v_mul_f32 v78, v78, v4
    v_mul_f32 v79, v79, v4
    v_cvt_pk_bf16_f32 v72, v72, v73
    v_cvt_pk_bf16_f32 v73, v74, v75
    v_cvt_pk_bf16_f32 v74, v76, v77
    v_cvt_pk_bf16_f32 v75, v78, v79
    ds_write_b128 v60, v[72:75] offset:64
    v_mul_f32 v80, v80, v4
    v_mul_f32 v81, v81, v4
    v_mul_f32 v82, v82, v4
    v_mul_f32 v83, v83, v4
    v_mul_f32 v84, v84, v4
    v_mul_f32 v85, v85, v4
    v_mul_f32 v86, v86, v4
    v_mul_f32 v87, v87, v4
    v_cvt_pk_bf16_f32 v80, v80, v81
    v_cvt_pk_bf16_f32 v81, v82, v83
    v_cvt_pk_bf16_f32 v82, v84, v85
    v_cvt_pk_bf16_f32 v83, v86, v87
    ds_write_b128 v60, v[80:83] offset:128
    v_mul_f32 v88, v88, v4
    v_mul_f32 v89, v89, v4
    v_mul_f32 v90, v90, v4
    v_mul_f32 v91, v91, v4
    v_mul_f32 v92, v92, v4
    v_mul_f32 v93, v93, v4
    v_mul_f32 v94, v94, v4
    v_mul_f32 v95, v95, v4
    v_cvt_pk_bf16_f32 v88, v88, v89
    v_cvt_pk_bf16_f32 v89, v90, v91
    v_cvt_pk_bf16_f32 v90, v92, v93
    v_cvt_pk_bf16_f32 v91, v94, v95
    ds_write_b128 v60, v[88:91] offset:192
    ds_read_b128 v[68:71], v61 offset:0
    ds_read_b128 v[76:79], v61 offset:1088
    ds_read_b128 v[84:87], v61 offset:2176
    ds_read_b128 v[92:95], v61 offset:3264
    s_waitcnt lgkmcnt(0)
    buffer_store_dwordx4 v[68:71], v62, s[16:19], 0 offen offset:0 sc1
    buffer_store_dwordx4 v[76:79], v62, s[16:19], 0 offen offset:1024 sc1
    buffer_store_dwordx4 v[84:87], v62, s[16:19], 0 offen offset:2048 sc1
    buffer_store_dwordx4 v[92:95], v62, s[16:19], 0 offen offset:3072 sc1
    v_mov_b32 v10, v5
    s_nop 1
    v_permlane32_swap_b32 v10, v5
    s_nop 1
    v_add_f32 v5, v5, v10
    v_mov_b32 v10, v5
    s_nop 1
    v_permlane16_swap_b32 v10, v5
    s_nop 1
    v_add_f32 v5, v5, v10
    v_cmp_nge_f32 vcc, s47, v5
    v_rcp_f32 v5, v5
    s_nop 7
    v_mul_f32 v96, v96, v5
    v_mul_f32 v97, v97, v5
    v_mul_f32 v98, v98, v5
    v_mul_f32 v99, v99, v5
    v_mul_f32 v100, v100, v5
    v_mul_f32 v101, v101, v5
    v_mul_f32 v102, v102, v5
    v_mul_f32 v103, v103, v5
    v_cvt_pk_bf16_f32 v96, v96, v97
    v_cvt_pk_bf16_f32 v97, v98, v99
    v_cvt_pk_bf16_f32 v98, v100, v101
    v_cvt_pk_bf16_f32 v99, v102, v103
    ds_write_b128 v60, v[96:99] offset:0
    v_mul_f32 v104, v104, v5
    v_mul_f32 v105, v105, v5
    v_mul_f32 v106, v106, v5
    v_mul_f32 v107, v107, v5
    v_mul_f32 v108, v108, v5
    v_mul_f32 v109, v109, v5
    v_mul_f32 v110, v110, v5
    v_mul_f32 v111, v111, v5
    v_cvt_pk_bf16_f32 v104, v104, v105
    v_cvt_pk_bf16_f32 v105, v106, v107
    v_cvt_pk_bf16_f32 v106, v108, v109
    v_cvt_pk_bf16_f32 v107, v110, v111
    ds_write_b128 v60, v[104:107] offset:64
    v_mul_f32 v112, v112, v5
    v_mul_f32 v113, v113, v5
    v_mul_f32 v114, v114, v5
    v_mul_f32 v115, v115, v5
    v_mul_f32 v116, v116, v5
    v_mul_f32 v117, v117, v5
    v_mul_f32 v118, v118, v5
    v_mul_f32 v119, v119, v5
    v_cvt_pk_bf16_f32 v112, v112, v113
    v_cvt_pk_bf16_f32 v113, v114, v115
    v_cvt_pk_bf16_f32 v114, v116, v117
    v_cvt_pk_bf16_f32 v115, v118, v119
    ds_write_b128 v60, v[112:115] offset:128
    v_mul_f32 v120, v120, v5
    v_mul_f32 v121, v121, v5
    v_mul_f32 v122, v122, v5
    v_mul_f32 v123, v123, v5
    v_mul_f32 v124, v124, v5
    v_mul_f32 v125, v125, v5
    v_mul_f32 v126, v126, v5
    v_mul_f32 v127, v127, v5
    v_cvt_pk_bf16_f32 v120, v120, v121
    v_cvt_pk_bf16_f32 v121, v122, v123
    v_cvt_pk_bf16_f32 v122, v124, v125
    v_cvt_pk_bf16_f32 v123, v126, v127
    ds_write_b128 v60, v[120:123] offset:192
    ds_read_b128 v[100:103], v61 offset:0
    ds_read_b128 v[108:111], v61 offset:1088
    ds_read_b128 v[116:119], v61 offset:2176
    ds_read_b128 v[124:127], v61 offset:3264
    s_waitcnt lgkmcnt(0)
    buffer_store_dwordx4 v[100:103], v62, s[16:19], s97 offen offset:0 sc1
    buffer_store_dwordx4 v[108:111], v62, s[16:19], s97 offen offset:1024 sc1
    buffer_store_dwordx4 v[116:119], v62, s[16:19], s97 offen offset:2048 sc1
    buffer_store_dwordx4 v[124:127], v62, s[16:19], s97 offen offset:3072 sc1
    v_mov_b32 v10, v6
    s_nop 1
    v_permlane32_swap_b32 v10, v6
    s_nop 1
    v_add_f32 v6, v6, v10
    v_mov_b32 v10, v6
    s_nop 1
    v_permlane16_swap_b32 v10, v6
    s_nop 1
    v_add_f32 v6, v6, v10
    v_cmp_nge_f32 vcc, s47, v6
    v_rcp_f32 v6, v6
    s_nop 7
    v_mul_f32 v128, v128, v6
    v_mul_f32 v129, v129, v6
    v_mul_f32 v130, v130, v6
    v_mul_f32 v131, v131, v6
    v_mul_f32 v132, v132, v6
    v_mul_f32 v133, v133, v6
    v_mul_f32 v134, v134, v6
    v_mul_f32 v135, v135, v6
    v_cvt_pk_bf16_f32 v128, v128, v129
    v_cvt_pk_bf16_f32 v129, v130, v131
    v_cvt_pk_bf16_f32 v130, v132, v133
    v_cvt_pk_bf16_f32 v131, v134, v135
    ds_write_b128 v60, v[128:131] offset:0
    v_mul_f32 v136, v136, v6
    v_mul_f32 v137, v137, v6
    v_mul_f32 v138, v138, v6
    v_mul_f32 v139, v139, v6
    v_mul_f32 v140, v140, v6
    v_mul_f32 v141, v141, v6
    v_mul_f32 v142, v142, v6
    v_mul_f32 v143, v143, v6
    v_cvt_pk_bf16_f32 v136, v136, v137
    v_cvt_pk_bf16_f32 v137, v138, v139
    v_cvt_pk_bf16_f32 v138, v140, v141
    v_cvt_pk_bf16_f32 v139, v142, v143
    ds_write_b128 v60, v[136:139] offset:64
    v_mul_f32 v144, v144, v6
    v_mul_f32 v145, v145, v6
    v_mul_f32 v146, v146, v6
    v_mul_f32 v147, v147, v6
    v_mul_f32 v148, v148, v6
    v_mul_f32 v149, v149, v6
    v_mul_f32 v150, v150, v6
    v_mul_f32 v151, v151, v6
    v_cvt_pk_bf16_f32 v144, v144, v145
    v_cvt_pk_bf16_f32 v145, v146, v147
    v_cvt_pk_bf16_f32 v146, v148, v149
    v_cvt_pk_bf16_f32 v147, v150, v151
    ds_write_b128 v60, v[144:147] offset:128
    v_mul_f32 v152, v152, v6
    v_mul_f32 v153, v153, v6
    v_mul_f32 v154, v154, v6
    v_mul_f32 v155, v155, v6
    v_mul_f32 v156, v156, v6
    v_mul_f32 v157, v157, v6
    v_mul_f32 v158, v158, v6
    v_mul_f32 v159, v159, v6
    v_cvt_pk_bf16_f32 v152, v152, v153
    v_cvt_pk_bf16_f32 v153, v154, v155
    v_cvt_pk_bf16_f32 v154, v156, v157
    v_cvt_pk_bf16_f32 v155, v158, v159
    ds_write_b128 v60, v[152:155] offset:192
    ds_read_b128 v[132:135], v61 offset:0
    ds_read_b128 v[140:143], v61 offset:1088
    ds_read_b128 v[148:151], v61 offset:2176
    ds_read_b128 v[156:159], v61 offset:3264
    s_waitcnt lgkmcnt(0)
    buffer_store_dwordx4 v[132:135], v62, s[16:19], s98 offen offset:0 sc1
    buffer_store_dwordx4 v[140:143], v62, s[16:19], s98 offen offset:1024 sc1
    buffer_store_dwordx4 v[148:151], v62, s[16:19], s98 offen offset:2048 sc1
    buffer_store_dwordx4 v[156:159], v62, s[16:19], s98 offen offset:3072 sc1
    v_mov_b32 v10, v7
    s_nop 1
    v_permlane32_swap_b32 v10, v7
    s_nop 1
    v_add_f32 v7, v7, v10
    v_mov_b32 v10, v7
    s_nop 1
    v_permlane16_swap_b32 v10, v7
    s_nop 1
    v_add_f32 v7, v7, v10
    v_cmp_nge_f32 vcc, s47, v7
    v_rcp_f32 v7, v7
    s_nop 7
    v_mul_f32 v160, v160, v7
    v_mul_f32 v161, v161, v7
    v_mul_f32 v162, v162, v7
    v_mul_f32 v163, v163, v7
    v_mul_f32 v164, v164, v7
    v_mul_f32 v165, v165, v7
    v_mul_f32 v166, v166, v7
    v_mul_f32 v167, v167, v7
    v_cvt_pk_bf16_f32 v160, v160, v161
    v_cvt_pk_bf16_f32 v161, v162, v163
    v_cvt_pk_bf16_f32 v162, v164, v165
    v_cvt_pk_bf16_f32 v163, v166, v167
    ds_write_b128 v60, v[160:163] offset:0
    v_mul_f32 v168, v168, v7
    v_mul_f32 v169, v169, v7
    v_mul_f32 v170, v170, v7
    v_mul_f32 v171, v171, v7
    v_mul_f32 v172, v172, v7
    v_mul_f32 v173, v173, v7
    v_mul_f32 v174, v174, v7
    v_mul_f32 v175, v175, v7
    v_cvt_pk_bf16_f32 v168, v168, v169
    v_cvt_pk_bf16_f32 v169, v170, v171
    v_cvt_pk_bf16_f32 v170, v172, v173
    v_cvt_pk_bf16_f32 v171, v174, v175
    ds_write_b128 v60, v[168:171] offset:64
    v_mul_f32 v176, v176, v7
    v_mul_f32 v177, v177, v7
    v_mul_f32 v178, v178, v7
    v_mul_f32 v179, v179, v7
    v_mul_f32 v180, v180, v7
    v_mul_f32 v181, v181, v7
    v_mul_f32 v182, v182, v7
    v_mul_f32 v183, v183, v7
    v_cvt_pk_bf16_f32 v176, v176, v177
    v_cvt_pk_bf16_f32 v177, v178, v179
    v_cvt_pk_bf16_f32 v178, v180, v181
    v_cvt_pk_bf16_f32 v179, v182, v183
    ds_write_b128 v60, v[176:179] offset:128
    v_mul_f32 v184, v184, v7
    v_mul_f32 v185, v185, v7
    v_mul_f32 v186, v186, v7
    v_mul_f32 v187, v187, v7
    v_mul_f32 v188, v188, v7
    v_mul_f32 v189, v189, v7
    v_mul_f32 v190, v190, v7
    v_mul_f32 v191, v191, v7
    v_cvt_pk_bf16_f32 v184, v184, v185
    v_cvt_pk_bf16_f32 v185, v186, v187
    v_cvt_pk_bf16_f32 v186, v188, v189
    v_cvt_pk_bf16_f32 v187, v190, v191
    ds_write_b128 v60, v[184:187] offset:192
    ds_read_b128 v[164:167], v61 offset:0
    ds_read_b128 v[172:175], v61 offset:1088
    ds_read_b128 v[180:183], v61 offset:2176
    ds_read_b128 v[188:191], v61 offset:3264
    s_waitcnt lgkmcnt(0)
    buffer_store_dwordx4 v[164:167], v62, s[16:19], s99 offen offset:0 sc1
    buffer_store_dwordx4 v[172:175], v62, s[16:19], s99 offen offset:1024 sc1
    buffer_store_dwordx4 v[180:183], v62, s[16:19], s99 offen offset:2048 sc1
    buffer_store_dwordx4 v[188:191], v62, s[16:19], s99 offen offset:3072 sc1
    v_mov_b32 v10, v8
    s_nop 1
    v_permlane32_swap_b32 v10, v8
    s_nop 1
    v_add_f32 v8, v8, v10
    v_mov_b32 v10, v8
    s_nop 1
    v_permlane16_swap_b32 v10, v8
    s_nop 1
    v_add_f32 v8, v8, v10
    v_cmp_nge_f32 vcc, s47, v8
    v_rcp_f32 v8, v8
    s_nop 7
    v_mul_f32 v192, v192, v8
    v_mul_f32 v193, v193, v8
    v_mul_f32 v194, v194, v8
    v_mul_f32 v195, v195, v8
    v_mul_f32 v196, v196, v8
    v_mul_f32 v197, v197, v8
    v_mul_f32 v198, v198, v8
    v_mul_f32 v199, v199, v8
    v_cvt_pk_bf16_f32 v192, v192, v193
    v_cvt_pk_bf16_f32 v193, v194, v195
    v_cvt_pk_bf16_f32 v194, v196, v197
    v_cvt_pk_bf16_f32 v195, v198, v199
    ds_write_b128 v60, v[192:195] offset:0
    v_mul_f32 v200, v200, v8
    v_mul_f32 v201, v201, v8
    v_mul_f32 v202, v202, v8
    v_mul_f32 v203, v203, v8
    v_mul_f32 v204, v204, v8
    v_mul_f32 v205, v205, v8
    v_mul_f32 v206, v206, v8
    v_mul_f32 v207, v207, v8
    v_cvt_pk_bf16_f32 v200, v200, v201
    v_cvt_pk_bf16_f32 v201, v202, v203
    v_cvt_pk_bf16_f32 v202, v204, v205
    v_cvt_pk_bf16_f32 v203, v206, v207
    ds_write_b128 v60, v[200:203] offset:64
    v_mul_f32 v208, v208, v8
    v_mul_f32 v209, v209, v8
    v_mul_f32 v210, v210, v8
    v_mul_f32 v211, v211, v8
    v_mul_f32 v212, v212, v8
    v_mul_f32 v213, v213, v8
    v_mul_f32 v214, v214, v8
    v_mul_f32 v215, v215, v8
    v_cvt_pk_bf16_f32 v208, v208, v209
    v_cvt_pk_bf16_f32 v209, v210, v211
    v_cvt_pk_bf16_f32 v210, v212, v213
    v_cvt_pk_bf16_f32 v211, v214, v215
    ds_write_b128 v60, v[208:211] offset:128
    v_mul_f32 v216, v216, v8
    v_mul_f32 v217, v217, v8
    v_mul_f32 v218, v218, v8
    v_mul_f32 v219, v219, v8
    v_mul_f32 v220, v220, v8
    v_mul_f32 v221, v221, v8
    v_mul_f32 v222, v222, v8
    v_mul_f32 v223, v223, v8
    v_cvt_pk_bf16_f32 v216, v216, v217
    v_cvt_pk_bf16_f32 v217, v218, v219
    v_cvt_pk_bf16_f32 v218, v220, v221
    v_cvt_pk_bf16_f32 v219, v222, v223
    ds_write_b128 v60, v[216:219] offset:192
    ds_read_b128 v[196:199], v61 offset:0
    ds_read_b128 v[204:207], v61 offset:1088
    ds_read_b128 v[212:215], v61 offset:2176
    ds_read_b128 v[220:223], v61 offset:3264
    s_waitcnt lgkmcnt(0)
    buffer_store_dwordx4 v[196:199], v62, s[16:19], s100 offen offset:0 sc1
    buffer_store_dwordx4 v[204:207], v62, s[16:19], s100 offen offset:1024 sc1
    buffer_store_dwordx4 v[212:215], v62, s[16:19], s100 offen offset:2048 sc1
    buffer_store_dwordx4 v[220:223], v62, s[16:19], s100 offen offset:3072 sc1
    v_mov_b32 v10, v9
    s_nop 1
    v_permlane32_swap_b32 v10, v9
    s_nop 1
    v_add_f32 v9, v9, v10
    v_mov_b32 v10, v9
    s_nop 1
    v_permlane16_swap_b32 v10, v9
    s_nop 1
    v_add_f32 v9, v9, v10
    v_cmp_nge_f32 vcc, s47, v9
    v_rcp_f32 v9, v9
    s_nop 7
    v_mul_f32 v224, v224, v9
    v_mul_f32 v225, v225, v9
    v_mul_f32 v226, v226, v9
    v_mul_f32 v227, v227, v9
    v_mul_f32 v228, v228, v9
    v_mul_f32 v229, v229, v9
    v_mul_f32 v230, v230, v9
    v_mul_f32 v231, v231, v9
    v_cvt_pk_bf16_f32 v224, v224, v225
    v_cvt_pk_bf16_f32 v225, v226, v227
    v_cvt_pk_bf16_f32 v226, v228, v229
    v_cvt_pk_bf16_f32 v227, v230, v231
    ds_write_b128 v60, v[224:227] offset:0
    v_mul_f32 v232, v232, v9
    v_mul_f32 v233, v233, v9
    v_mul_f32 v234, v234, v9
    v_mul_f32 v235, v235, v9
    v_mul_f32 v236, v236, v9
    v_mul_f32 v237, v237, v9
    v_mul_f32 v238, v238, v9
    v_mul_f32 v239, v239, v9
    v_cvt_pk_bf16_f32 v232, v232, v233
    v_cvt_pk_bf16_f32 v233, v234, v235
    v_cvt_pk_bf16_f32 v234, v236, v237
    v_cvt_pk_bf16_f32 v235, v238, v239
    ds_write_b128 v60, v[232:235] offset:64
    v_mul_f32 v240, v240, v9
    v_mul_f32 v241, v241, v9
    v_mul_f32 v242, v242, v9
    v_mul_f32 v243, v243, v9
    v_mul_f32 v244, v244, v9
    v_mul_f32 v245, v245, v9
    v_mul_f32 v246, v246, v9
    v_mul_f32 v247, v247, v9
    v_cvt_pk_bf16_f32 v240, v240, v241
    v_cvt_pk_bf16_f32 v241, v242, v243
    v_cvt_pk_bf16_f32 v242, v244, v245
    v_cvt_pk_bf16_f32 v243, v246, v247
    ds_write_b128 v60, v[240:243] offset:128
    v_mul_f32 v248, v248, v9
    v_mul_f32 v249, v249, v9
    v_mul_f32 v250, v250, v9
    v_mul_f32 v251, v251, v9
    v_mul_f32 v252, v252, v9
    v_mul_f32 v253, v253, v9
    v_mul_f32 v254, v254, v9
    v_mul_f32 v255, v255, v9
    v_cvt_pk_bf16_f32 v248, v248, v249
    v_cvt_pk_bf16_f32 v249, v250, v251
    v_cvt_pk_bf16_f32 v250, v252, v253
    v_cvt_pk_bf16_f32 v251, v254, v255
    ds_write_b128 v60, v[248:251] offset:192
    ds_read_b128 v[228:231], v61 offset:0
    ds_read_b128 v[236:239], v61 offset:1088
    ds_read_b128 v[244:247], v61 offset:2176
    ds_read_b128 v[252:255], v61 offset:3264
    s_waitcnt lgkmcnt(0)
    buffer_store_dwordx4 v[228:231], v62, s[16:19], s101 offen offset:0 sc1
    buffer_store_dwordx4 v[236:239], v62, s[16:19], s101 offen offset:1024 sc1
    buffer_store_dwordx4 v[244:247], v62, s[16:19], s101 offen offset:2048 sc1
    buffer_store_dwordx4 v[252:255], v62, s[16:19], s101 offen offset:3072 sc1
    s_endpgm
.section .rodata,"a"
.p2align 6
.amdhsa_kernel standalone__mha_softmax__near_ridge_kernel
  .amdhsa_next_free_vgpr 508
  .amdhsa_next_free_sgpr 102
  .amdhsa_accum_offset 256
  .amdhsa_group_segment_fixed_size 0
  .amdhsa_kernarg_size 48
  .amdhsa_user_sgpr_count 2
  .amdhsa_user_sgpr_kernarg_segment_ptr 1
  .amdhsa_system_sgpr_workgroup_id_x 1
.end_amdhsa_kernel
```
